```python
import torch

def _softmax(x, axis=-1):
    return torch.softmax(x, dim=axis)
def _gelu(x):
    return torch.nn.functional.gelu(x, approximate="tanh")
def _silu(x):
    return torch.nn.functional.silu(x)
def _sigmoid(x):
    return torch.sigmoid(x)
def _layernorm(x, axis=-1, eps=1e-5):
    m = x.mean(dim=axis, keepdim=True)
    v = x.var(dim=axis, keepdim=True, unbiased=False)
    return (x - m) / torch.sqrt(v + eps)
def _scatter_add(tgt, idx, src, axis=0):
    return tgt.clone().index_add_(axis, idx, src)
def _segment_sum(src, seg, n):
    out = torch.zeros((n,) + src.shape[1:], dtype=src.dtype)
    return out.index_add_(0, seg, src)
def _pad(x, pw):
    flat = tuple(v for pair in reversed(pw) for v in pair)
    return torch.nn.functional.pad(x, flat)

kernel_name = 'sequential_preLN__linear_kernel_hedgehog__dense_activation_squared_relu__prompt'

def setup_inputs():

    _w = (lambda a: (lambda t: t.to(torch.bfloat16) if t.is_floating_point() else t)(torch.as_tensor(a)))
    def _A_setup():
        B, S, D, H = 1, 2048, 1024, 32
        Dh = D // H
        return {
            "x": _w((lambda *s: torch.randn(*s, dtype=torch.bfloat16) * 0.05)(B, S, D)),
            "wqkv": _w((lambda *s: torch.randn(*s, dtype=torch.bfloat16) * 0.2)(D, 3 * D)),
            "w_phi": _w((lambda *s: torch.randn(*s, dtype=torch.bfloat16) * 0.2)(H, Dh, Dh) * (Dh ** -0.5)),
            "wo": _w((lambda *s: torch.randn(*s, dtype=torch.bfloat16) * 0.05)(D, D)),
        }
    _A_in = _A_setup()

    def _B_setup():
        B, S, D, F = 1, 2048, 1024, 3584
        return {
            "x": _w((lambda *s: torch.randn(*s, dtype=torch.bfloat16) * 0.05)(B, S, D)),
            "w1": _w((lambda *s: torch.randn(*s, dtype=torch.bfloat16) * 0.05)(D, F)),
            "b1": _w((lambda *s: torch.randn(*s, dtype=torch.bfloat16) * 0.4)(F)),
            "w2": _w((lambda *s: torch.randn(*s, dtype=torch.bfloat16) * 0.05)(F, D)),
            "b2": _w((lambda *s: torch.randn(*s, dtype=torch.bfloat16) * 3.2)(D)),
        }
    _B_in = _B_setup()

    return {
        "A_x": _A_in["x"],
        "A_wqkv": _A_in["wqkv"],
        "A_w_phi": _A_in["w_phi"],
        "A_wo": _A_in["wo"],
        "B_x": _B_in["x"],
        "B_w1": _B_in["w1"],
        "B_b1": _B_in["b1"],
        "B_w2": _B_in["w2"],
        "B_b2": _B_in["b2"],
    }

def reference(A_x, A_wqkv, A_w_phi, A_wo, B_x, B_w1, B_b1, B_w2, B_b2):
    def _A_ref(x, wqkv, w_phi, wo):
        B, S, D = x.shape
        H = 32; Dh = D // H
        qkv = (lambda x, *d: x.permute(*d))((x @ wqkv).reshape(B, S, 3, H, Dh), 2, 0, 3, 1, 4)
        q, k, v = qkv[0], qkv[1], qkv[2]
        pq = torch.einsum("bhsd,hdf->bhsf", q, w_phi)
        pk = torch.einsum("bhsd,hdf->bhsf", k, w_phi)
        phi_q = torch.concatenate([_softmax(pq, axis=-1), _softmax(-pq, axis=-1)], axis=-1)
        phi_k = torch.concatenate([_softmax(pk, axis=-1), _softmax(-pk, axis=-1)], axis=-1)
        kv = torch.einsum("bhsf,bhsd->bhfd", phi_k, v)
        z  = torch.einsum("bhsf->bhf", phi_k)
        num = torch.einsum("bhqf,bhfd->bhqd", phi_q, kv)
        den = torch.einsum("bhqf,bhf->bhq", phi_q, z)[..., None] + 1e-6
        o = num / den
        return (lambda x, *d: x.permute(*d))(o, 0, 2, 1, 3).reshape(B, S, D) @ wo

    def _B_ref(x, w1, b1, w2, b2):
        h = torch.einsum("bsd,df->bsf", x, w1) + b1
        zero = torch.zeros_like(h)
        r = torch.where(h > zero, h, zero)
        h = r * r
        out = torch.einsum("bsf,fd->bsd", h, w2) + b2
        return out

    x = A_x
    h = x + _A_ref(_layernorm(x, axis=-1), A_wqkv, A_w_phi, A_wo)
    h2 = h + _B_ref(_layernorm(h, axis=-1), B_w1, B_b1, B_w2, B_b2)
    return h2
```

```asm
; @launch kernel=k0_kernel grid=(256,1,1) block=(256,1,1) lds=1024
; @launch kernel=ka_kernel grid=(256,1,1) block=(512,1,1) lds=155904
.amdgcn_target "amdgcn-amd-amdhsa--gfx950"
.text
.globl k0_kernel
.p2align 8
.type k0_kernel,@function
k0_kernel:
CODE_BEGIN:
    s_cmp_ge_u32 s2, 256
    s_cbranch_scc1 K0_end
    s_load_dwordx2 s[30:31], s[0:1], 0
    s_load_dwordx2 s[34:35], s[0:1], 88
    s_load_dwordx2 s[32:33], s[0:1], 8
    s_load_dwordx2 s[36:37], s[0:1], 24
    s_load_dwordx2 s[38:39], s[0:1], 40
    v_and_b32 v1, 63, v0
    v_lshrrev_b32 v2, 6, v0
    s_nop 0
    v_readfirstlane_b32 s16, v2
    v_and_b32 v2, 7, v0
    v_lshrrev_b32 v3, 3, v0
    s_lshl_b32 s20, s2, 3
    v_add_u32 v4, s20, v2
    v_lshlrev_b32 v4, 11, v4
    v_lshl_add_u32 v4, v3, 6, v4
    s_waitcnt lgkmcnt(0)
    s_mov_b32 s4, s30
    s_mov_b32 s5, s31
    s_mov_b32 s6, 0x400000
    s_mov_b32 s7, 0x20000
    buffer_load_dwordx4 v[16:19], v4, s[4:7], 0 offen offset:0
    buffer_load_dwordx4 v[20:23], v4, s[4:7], 0 offen offset:16
    buffer_load_dwordx4 v[24:27], v4, s[4:7], 0 offen offset:32
    buffer_load_dwordx4 v[28:31], v4, s[4:7], 0 offen offset:48
    s_lshl_b32 s21, s2, 2
    s_add_u32 s21, s21, s16
    s_lshl_b32 s21, s21, 13
    v_lshlrev_b32 v5, 7, v1
    s_mov_b32 s12, s32
    s_mov_b32 s13, s33
    s_mov_b32 s14, 0x600000
    s_mov_b32 s15, 0x20000
    buffer_load_dword v10, v5, s[12:15], s21 offen
    s_mov_b32 s12, s32
    s_mov_b32 s13, s33
    s_mov_b32 s14, 0x600000
    s_mov_b32 s15, 0x20000
    s_and_b32 s22, s2, 7
    s_lshr_b32 s23, s2, 3
    s_and_b32 s26, s22, 2
    s_cmp_eq_u32 s26, 0
    s_cselect_b32 s26, 0, 0x1000000
    s_lshr_b32 s22, s22, 2
    s_lshl_b32 s22, s22, 10
    s_add_u32 s22, s22, 384
    s_mul_i32 s23, s23, 196608
    s_add_u32 s22, s22, s23
    s_add_u32 s22, s22, s26
    s_cmp_ge_u32 s16, 2
    s_cselect_b32 s26, 0x1000000, 0
    s_add_u32 s22, s22, s26
    s_lshl_b32 s26, s16, 12
    s_add_u32 s22, s22, s26
    v_and_b32 v6, 31, v1
    s_mov_b32 s26, 6144
    v_mul_lo_u32 v6, v6, s26
    v_lshrrev_b32 v7, 5, v1
    v_lshl_add_u32 v6, v7, 11, v6
    buffer_load_dword v36, v6, s[12:15], s22 offen
    s_getpc_b64 s[24:25]
K0_pc:
    s_sub_u32 s24, s24, K0_pc-CODE_BEGIN
    s_subb_u32 s25, s25, 0
    s_mov_b32 s26, CODE_END-CODE_BEGIN
    s_mov_b32 s27, 0x20000
    s_lshr_b32 s21, s2, 3
    s_and_b32 s21, s21, 15
    s_lshl_b32 s21, s21, 13
    buffer_load_dword v11, v5, s[24:27], s21 offen
    s_mov_b32 s8, s34
    s_mov_b32 s9, s35
    s_mov_b32 s10, 0x400000
    s_mov_b32 s11, 0x20000
    s_waitcnt vmcnt(3)
    v_lshlrev_b32 v64, 16, v16
    v_and_b32 v65, 0xffff0000, v16
    v_lshlrev_b32 v66, 16, v17
    v_and_b32 v67, 0xffff0000, v17
    v_lshlrev_b32 v68, 16, v18
    v_and_b32 v69, 0xffff0000, v18
    v_lshlrev_b32 v70, 16, v19
    v_and_b32 v71, 0xffff0000, v19
    v_lshlrev_b32 v72, 16, v20
    v_and_b32 v73, 0xffff0000, v20
    v_lshlrev_b32 v74, 16, v21
    v_and_b32 v75, 0xffff0000, v21
    v_lshlrev_b32 v76, 16, v22
    v_and_b32 v77, 0xffff0000, v22
    v_lshlrev_b32 v78, 16, v23
    v_and_b32 v79, 0xffff0000, v23
    v_lshlrev_b32 v80, 16, v24
    v_and_b32 v81, 0xffff0000, v24
    v_lshlrev_b32 v82, 16, v25
    v_and_b32 v83, 0xffff0000, v25
    v_lshlrev_b32 v84, 16, v26
    v_and_b32 v85, 0xffff0000, v26
    v_lshlrev_b32 v86, 16, v27
    v_and_b32 v87, 0xffff0000, v27
    v_lshlrev_b32 v88, 16, v28
    v_and_b32 v89, 0xffff0000, v28
    v_lshlrev_b32 v90, 16, v29
    v_and_b32 v91, 0xffff0000, v29
    v_lshlrev_b32 v92, 16, v30
    v_and_b32 v93, 0xffff0000, v30
    v_lshlrev_b32 v94, 16, v31
    v_and_b32 v95, 0xffff0000, v31
    v_pk_add_f32 v[40:41], v[64:65], v[80:81]
    v_pk_add_f32 v[42:43], v[66:67], v[82:83]
    v_pk_add_f32 v[44:45], v[68:69], v[84:85]
    v_pk_add_f32 v[46:47], v[70:71], v[86:87]
    v_pk_add_f32 v[48:49], v[72:73], v[88:89]
    v_pk_add_f32 v[50:51], v[74:75], v[90:91]
    v_pk_add_f32 v[52:53], v[76:77], v[92:93]
    v_pk_add_f32 v[54:55], v[78:79], v[94:95]
    v_pk_add_f32 v[40:41], v[40:41], v[48:49]
    v_pk_add_f32 v[42:43], v[42:43], v[50:51]
    v_pk_add_f32 v[44:45], v[44:45], v[52:53]
    v_pk_add_f32 v[46:47], v[46:47], v[54:55]
    v_pk_add_f32 v[40:41], v[40:41], v[44:45]
    v_pk_add_f32 v[42:43], v[42:43], v[46:47]
    v_pk_add_f32 v[40:41], v[40:41], v[42:43]
    v_add_f32 v6, v40, v41
    s_nop 1
    v_add_f32_dpp v6, v6, v6 row_ror:8 row_mask:0xf bank_mask:0xf
    v_mov_b32 v7, v6
    s_nop 1
    v_permlane16_swap_b32 v6, v7
    v_add_f32 v6, v6, v7
    v_mov_b32 v7, v6
    s_nop 1
    v_permlane32_swap_b32 v6, v7
    v_add_f32 v6, v6, v7
    v_lshlrev_b32 v8, 2, v2
    s_lshl_b32 s21, s16, 5
    v_add_u32 v9, s21, v8
    ds_write_b32 v9, v6
    s_waitcnt lgkmcnt(0)
    s_barrier
    ds_read_b32 v12, v8
    ds_read_b32 v13, v8 offset:32
    ds_read_b32 v14, v8 offset:64
    ds_read_b32 v15, v8 offset:96
    s_waitcnt lgkmcnt(0)
    v_add_f32 v12, v12, v13
    v_add_f32 v14, v14, v15
    v_add_f32 v12, v12, v14
    v_mul_f32 v12, 0x3a800000, v12
    v_pk_add_f32 v[96:97], v[64:65], v[12:13] op_sel_hi:[1,0] neg_lo:[0,1] neg_hi:[0,1]
    v_pk_add_f32 v[98:99], v[66:67], v[12:13] op_sel_hi:[1,0] neg_lo:[0,1] neg_hi:[0,1]
    v_pk_add_f32 v[100:101], v[68:69], v[12:13] op_sel_hi:[1,0] neg_lo:[0,1] neg_hi:[0,1]
    v_pk_add_f32 v[102:103], v[70:71], v[12:13] op_sel_hi:[1,0] neg_lo:[0,1] neg_hi:[0,1]
    v_pk_add_f32 v[104:105], v[72:73], v[12:13] op_sel_hi:[1,0] neg_lo:[0,1] neg_hi:[0,1]
    v_pk_add_f32 v[106:107], v[74:75], v[12:13] op_sel_hi:[1,0] neg_lo:[0,1] neg_hi:[0,1]
    v_pk_add_f32 v[108:109], v[76:77], v[12:13] op_sel_hi:[1,0] neg_lo:[0,1] neg_hi:[0,1]
    v_pk_add_f32 v[110:111], v[78:79], v[12:13] op_sel_hi:[1,0] neg_lo:[0,1] neg_hi:[0,1]
    v_pk_add_f32 v[112:113], v[80:81], v[12:13] op_sel_hi:[1,0] neg_lo:[0,1] neg_hi:[0,1]
    v_pk_add_f32 v[114:115], v[82:83], v[12:13] op_sel_hi:[1,0] neg_lo:[0,1] neg_hi:[0,1]
    v_pk_add_f32 v[116:117], v[84:85], v[12:13] op_sel_hi:[1,0] neg_lo:[0,1] neg_hi:[0,1]
    v_pk_add_f32 v[118:119], v[86:87], v[12:13] op_sel_hi:[1,0] neg_lo:[0,1] neg_hi:[0,1]
    v_pk_add_f32 v[120:121], v[88:89], v[12:13] op_sel_hi:[1,0] neg_lo:[0,1] neg_hi:[0,1]
    v_pk_add_f32 v[122:123], v[90:91], v[12:13] op_sel_hi:[1,0] neg_lo:[0,1] neg_hi:[0,1]
    v_pk_add_f32 v[124:125], v[92:93], v[12:13] op_sel_hi:[1,0] neg_lo:[0,1] neg_hi:[0,1]
    v_pk_add_f32 v[126:127], v[94:95], v[12:13] op_sel_hi:[1,0] neg_lo:[0,1] neg_hi:[0,1]
    v_pk_mul_f32 v[40:41], v[96:97], v[96:97]
    v_pk_mul_f32 v[42:43], v[98:99], v[98:99]
    v_pk_mul_f32 v[44:45], v[100:101], v[100:101]
    v_pk_mul_f32 v[46:47], v[102:103], v[102:103]
    v_pk_fma_f32 v[40:41], v[104:105], v[104:105], v[40:41]
    v_pk_fma_f32 v[42:43], v[106:107], v[106:107], v[42:43]
    v_pk_fma_f32 v[44:45], v[108:109], v[108:109], v[44:45]
    v_pk_fma_f32 v[46:47], v[110:111], v[110:111], v[46:47]
    v_pk_fma_f32 v[40:41], v[112:113], v[112:113], v[40:41]
    v_pk_fma_f32 v[42:43], v[114:115], v[114:115], v[42:43]
    v_pk_fma_f32 v[44:45], v[116:117], v[116:117], v[44:45]
    v_pk_fma_f32 v[46:47], v[118:119], v[118:119], v[46:47]
    v_pk_fma_f32 v[40:41], v[120:121], v[120:121], v[40:41]
    v_pk_fma_f32 v[42:43], v[122:123], v[122:123], v[42:43]
    v_pk_fma_f32 v[44:45], v[124:125], v[124:125], v[44:45]
    v_pk_fma_f32 v[46:47], v[126:127], v[126:127], v[46:47]
    v_pk_add_f32 v[40:41], v[40:41], v[42:43]
    v_pk_add_f32 v[44:45], v[44:45], v[46:47]
    v_pk_add_f32 v[40:41], v[40:41], v[44:45]
    v_add_f32 v6, v40, v41
    s_nop 1
    v_add_f32_dpp v6, v6, v6 row_ror:8 row_mask:0xf bank_mask:0xf
    v_mov_b32 v7, v6
    s_nop 1
    v_permlane16_swap_b32 v6, v7
    v_add_f32 v6, v6, v7
    v_mov_b32 v7, v6
    s_nop 1
    v_permlane32_swap_b32 v6, v7
    v_add_f32 v6, v6, v7
    ds_write_b32 v9, v6 offset:128
    s_waitcnt lgkmcnt(0)
    s_barrier
    ds_read_b32 v13, v8 offset:128
    ds_read_b32 v14, v8 offset:160
    ds_read_b32 v15, v8 offset:192
    ds_read_b32 v6, v8 offset:224
    s_waitcnt lgkmcnt(0)
    v_add_f32 v13, v13, v14
    v_add_f32 v15, v15, v6
    v_add_f32 v13, v13, v15
    v_mul_f32 v14, 0x3a800000, v13
    v_cvt_pk_bf16_f32 v12, v12, v12
    v_lshlrev_b32 v12, 16, v12
    v_cvt_pk_bf16_f32 v14, v14, v14
    v_lshlrev_b32 v14, 16, v14
    v_add_f32 v14, 0x3727c5ac, v14
    v_cvt_pk_bf16_f32 v14, v14, v14
    v_lshlrev_b32 v14, 16, v14
    v_sqrt_f32 v14, v14
    s_nop 0
    v_cvt_pk_bf16_f32 v14, v14, v14
    v_lshlrev_b32 v14, 16, v14
    v_rcp_f32 v14, v14
    v_pk_add_f32 v[64:65], v[64:65], v[12:13] op_sel_hi:[1,0] neg_lo:[0,1] neg_hi:[0,1]
    v_pk_add_f32 v[66:67], v[66:67], v[12:13] op_sel_hi:[1,0] neg_lo:[0,1] neg_hi:[0,1]
    v_pk_add_f32 v[68:69], v[68:69], v[12:13] op_sel_hi:[1,0] neg_lo:[0,1] neg_hi:[0,1]
    v_pk_add_f32 v[70:71], v[70:71], v[12:13] op_sel_hi:[1,0] neg_lo:[0,1] neg_hi:[0,1]
    v_pk_add_f32 v[72:73], v[72:73], v[12:13] op_sel_hi:[1,0] neg_lo:[0,1] neg_hi:[0,1]
    v_pk_add_f32 v[74:75], v[74:75], v[12:13] op_sel_hi:[1,0] neg_lo:[0,1] neg_hi:[0,1]
    v_pk_add_f32 v[76:77], v[76:77], v[12:13] op_sel_hi:[1,0] neg_lo:[0,1] neg_hi:[0,1]
    v_pk_add_f32 v[78:79], v[78:79], v[12:13] op_sel_hi:[1,0] neg_lo:[0,1] neg_hi:[0,1]
    v_pk_add_f32 v[80:81], v[80:81], v[12:13] op_sel_hi:[1,0] neg_lo:[0,1] neg_hi:[0,1]
    v_pk_add_f32 v[82:83], v[82:83], v[12:13] op_sel_hi:[1,0] neg_lo:[0,1] neg_hi:[0,1]
    v_pk_add_f32 v[84:85], v[84:85], v[12:13] op_sel_hi:[1,0] neg_lo:[0,1] neg_hi:[0,1]
    v_pk_add_f32 v[86:87], v[86:87], v[12:13] op_sel_hi:[1,0] neg_lo:[0,1] neg_hi:[0,1]
    v_pk_add_f32 v[88:89], v[88:89], v[12:13] op_sel_hi:[1,0] neg_lo:[0,1] neg_hi:[0,1]
    v_pk_add_f32 v[90:91], v[90:91], v[12:13] op_sel_hi:[1,0] neg_lo:[0,1] neg_hi:[0,1]
    v_pk_add_f32 v[92:93], v[92:93], v[12:13] op_sel_hi:[1,0] neg_lo:[0,1] neg_hi:[0,1]
    v_pk_add_f32 v[94:95], v[94:95], v[12:13] op_sel_hi:[1,0] neg_lo:[0,1] neg_hi:[0,1]
    v_cvt_pk_bf16_f32 v96, v64, v65
    v_cvt_pk_bf16_f32 v97, v66, v67
    v_cvt_pk_bf16_f32 v98, v68, v69
    v_cvt_pk_bf16_f32 v99, v70, v71
    v_cvt_pk_bf16_f32 v100, v72, v73
    v_cvt_pk_bf16_f32 v101, v74, v75
    v_cvt_pk_bf16_f32 v102, v76, v77
    v_cvt_pk_bf16_f32 v103, v78, v79
    v_cvt_pk_bf16_f32 v104, v80, v81
    v_cvt_pk_bf16_f32 v105, v82, v83
    v_cvt_pk_bf16_f32 v106, v84, v85
    v_cvt_pk_bf16_f32 v107, v86, v87
    v_cvt_pk_bf16_f32 v108, v88, v89
    v_cvt_pk_bf16_f32 v109, v90, v91
    v_cvt_pk_bf16_f32 v110, v92, v93
    v_cvt_pk_bf16_f32 v111, v94, v95
    v_lshlrev_b32 v64, 16, v96
    v_and_b32 v65, 0xffff0000, v96
    v_lshlrev_b32 v66, 16, v97
    v_and_b32 v67, 0xffff0000, v97
    v_lshlrev_b32 v68, 16, v98
    v_and_b32 v69, 0xffff0000, v98
    v_lshlrev_b32 v70, 16, v99
    v_and_b32 v71, 0xffff0000, v99
    v_lshlrev_b32 v72, 16, v100
    v_and_b32 v73, 0xffff0000, v100
    v_lshlrev_b32 v74, 16, v101
    v_and_b32 v75, 0xffff0000, v101
    v_lshlrev_b32 v76, 16, v102
    v_and_b32 v77, 0xffff0000, v102
    v_lshlrev_b32 v78, 16, v103
    v_and_b32 v79, 0xffff0000, v103
    v_lshlrev_b32 v80, 16, v104
    v_and_b32 v81, 0xffff0000, v104
    v_lshlrev_b32 v82, 16, v105
    v_and_b32 v83, 0xffff0000, v105
    v_lshlrev_b32 v84, 16, v106
    v_and_b32 v85, 0xffff0000, v106
    v_lshlrev_b32 v86, 16, v107
    v_and_b32 v87, 0xffff0000, v107
    v_lshlrev_b32 v88, 16, v108
    v_and_b32 v89, 0xffff0000, v108
    v_lshlrev_b32 v90, 16, v109
    v_and_b32 v91, 0xffff0000, v109
    v_lshlrev_b32 v92, 16, v110
    v_and_b32 v93, 0xffff0000, v110
    v_lshlrev_b32 v94, 16, v111
    v_and_b32 v95, 0xffff0000, v111
    v_pk_mul_f32 v[64:65], v[64:65], v[14:15] op_sel_hi:[1,0]
    v_pk_mul_f32 v[66:67], v[66:67], v[14:15] op_sel_hi:[1,0]
    v_pk_mul_f32 v[68:69], v[68:69], v[14:15] op_sel_hi:[1,0]
    v_pk_mul_f32 v[70:71], v[70:71], v[14:15] op_sel_hi:[1,0]
    v_pk_mul_f32 v[72:73], v[72:73], v[14:15] op_sel_hi:[1,0]
    v_pk_mul_f32 v[74:75], v[74:75], v[14:15] op_sel_hi:[1,0]
    v_pk_mul_f32 v[76:77], v[76:77], v[14:15] op_sel_hi:[1,0]
    v_pk_mul_f32 v[78:79], v[78:79], v[14:15] op_sel_hi:[1,0]
    v_pk_mul_f32 v[80:81], v[80:81], v[14:15] op_sel_hi:[1,0]
    v_pk_mul_f32 v[82:83], v[82:83], v[14:15] op_sel_hi:[1,0]
    v_pk_mul_f32 v[84:85], v[84:85], v[14:15] op_sel_hi:[1,0]
    v_pk_mul_f32 v[86:87], v[86:87], v[14:15] op_sel_hi:[1,0]
    v_pk_mul_f32 v[88:89], v[88:89], v[14:15] op_sel_hi:[1,0]
    v_pk_mul_f32 v[90:91], v[90:91], v[14:15] op_sel_hi:[1,0]
    v_pk_mul_f32 v[92:93], v[92:93], v[14:15] op_sel_hi:[1,0]
    v_pk_mul_f32 v[94:95], v[94:95], v[14:15] op_sel_hi:[1,0]
    v_cvt_pk_bf16_f32 v16, v64, v65
    v_cvt_pk_bf16_f32 v17, v66, v67
    v_cvt_pk_bf16_f32 v18, v80, v81
    v_cvt_pk_bf16_f32 v19, v82, v83
    v_cvt_pk_bf16_f32 v20, v68, v69
    v_cvt_pk_bf16_f32 v21, v70, v71
    v_cvt_pk_bf16_f32 v22, v84, v85
    v_cvt_pk_bf16_f32 v23, v86, v87
    v_cvt_pk_bf16_f32 v24, v72, v73
    v_cvt_pk_bf16_f32 v25, v74, v75
    v_cvt_pk_bf16_f32 v26, v88, v89
    v_cvt_pk_bf16_f32 v27, v90, v91
    v_cvt_pk_bf16_f32 v28, v76, v77
    v_cvt_pk_bf16_f32 v29, v78, v79
    v_cvt_pk_bf16_f32 v30, v92, v93
    v_cvt_pk_bf16_f32 v31, v94, v95
    s_lshr_b32 s20, s2, 1
    s_lshl_b32 s20, s20, 15
    s_and_b32 s21, s2, 1
    s_lshl_b32 s21, s21, 7
    s_add_u32 s20, s20, s21
    v_lshlrev_b32 v4, 10, v3
    v_lshl_add_u32 v4, v2, 4, v4
    v_add_u32 v4, s20, v4
    buffer_store_dwordx4 v[16:19], v4, s[8:11], 0 offen offset:0 sc1
    buffer_store_dwordx4 v[20:23], v4, s[8:11], 0 offen offset:256 sc1
    buffer_store_dwordx4 v[24:27], v4, s[8:11], 0 offen offset:512 sc1
    buffer_store_dwordx4 v[28:31], v4, s[8:11], 0 offen offset:768 sc1
    s_add_u32 s12, s34, 0x1e00000
    s_addc_u32 s13, s35, 0
    s_mov_b32 s14, 0x20000
    s_mov_b32 s15, 0x20000
    s_lshl_b32 s21, s2, 8
    v_lshlrev_b32 v34, 16, v0
    v_add_u32 v34, s21, v34
    v_mov_b32 v35, 0
    v_cmp_gt_u32 vcc, 2, v0
    s_nop 3
    s_and_saveexec_b64 s[40:41], vcc
    s_cbranch_execz K0_nz
    buffer_store_dword v35, v34, s[12:15], 0 offen sc1
K0_nz:
    s_mov_b64 exec, s[40:41]
K0_end:
    s_endpgm
.globl ka_kernel
.p2align 8
.type ka_kernel,@function
ka_kernel:
    s_cmp_ge_u32 s2, 256
    s_cbranch_scc1 K4_end
    s_load_dwordx2 s[34:35], s[0:1], 88
    s_load_dwordx2 s[32:33], s[0:1], 8
    s_load_dwordx2 s[36:37], s[0:1], 16
    s_load_dwordx2 s[60:61], s[0:1], 24
    s_load_dwordx2 s[62:63], s[0:1], 56
    s_load_dwordx2 s[64:65], s[0:1], 0
    s_load_dwordx2 s[68:69], s[0:1], 40
    v_and_b32 v1, 63, v0
    v_lshrrev_b32 v2, 6, v0
    s_nop 0
    v_readfirstlane_b32 s16, v2
    s_and_b32 s40, s2, 7
    s_lshr_b32 s41, s2, 3
    s_lshr_b32 s66, s41, 3
    s_and_b32 s67, s41, 7
    s_and_b32 s42, s40, 1
    s_lshl_b32 s42, s42, 3
    s_and_b32 s43, s41, 7
    s_add_u32 s17, s42, s43
    s_lshr_b32 s42, s40, 1
    s_lshl_b32 s42, s42, 2
    s_lshr_b32 s43, s41, 3
    s_add_u32 s18, s42, s43
    s_lshl_b32 s44, s17, 3
    s_lshl_b32 s45, s18, 7
    s_add_u32 s45, s45, 0
    s_lshl_b32 s46, s18, 7
    s_add_u32 s46, s46, 2048
    s_lshl_b32 s47, s18, 7
    s_add_u32 s47, s47, 4096
    s_waitcnt lgkmcnt(0)
    s_mov_b32 s4, s34
    s_mov_b32 s5, s35
    s_mov_b32 s6, 0x400000
    s_mov_b32 s7, 0x20000
    s_mov_b32 s8, s32
    s_mov_b32 s9, s33
    s_mov_b32 s10, 0x600000
    s_mov_b32 s11, 0x20000
    s_cmp_ge_u32 s16, 4
    s_cbranch_scc1 K1_loader
    s_lshr_b32 s38, s16, 1
    s_and_b32 s39, s16, 1
    s_mul_i32 s25, s38, 8192
    v_lshlrev_b32 v2, 4, v1
    v_add_u32 v2, s25, v2
    v_bfe_u32 v9, v1, 1, 1
    v_bfe_u32 v10, v1, 3, 2
    v_lshlrev_b32 v10, 1, v10
    v_xor_b32 v9, v9, v10
    v_lshrrev_b32 v10, 2, v1
    v_lshlrev_b32 v3, 7, v10
    v_lshl_add_u32 v3, v9, 4, v3
    v_and_b32 v10, 1, v1
    v_lshl_add_u32 v3, v10, 3, v3
    s_lshl_b32 s25, s39, 6
    v_xor_b32 v3, s25, v3
    v_xor_b32 v4, 32, v3
    s_mov_b32 s12, s36
    s_mov_b32 s13, s37
    s_mov_b32 s14, 0x10000
    s_mov_b32 s15, 0x20000
    s_lshl_b32 s45, s18, 1
    s_add_u32 s45, s45, s39
    s_lshl_b32 s41, s45, 11
    v_lshrrev_b32 v9, 4, v1
    v_lshlrev_b32 v9, 8, v9
    v_and_b32 v10, 15, v1
    v_lshl_add_u32 v9, v10, 1, v9
    v_add_u32 v9, s41, v9
    buffer_load_ushort v96, v9, s[12:15], 0 offen offset:0
    buffer_load_ushort v97, v9, s[12:15], 0 offen offset:64
    buffer_load_ushort v98, v9, s[12:15], 0 offen offset:128
    buffer_load_ushort v99, v9, s[12:15], 0 offen offset:192
    buffer_load_ushort v100, v9, s[12:15], 0 offen offset:1024
    buffer_load_ushort v101, v9, s[12:15], 0 offen offset:1088
    buffer_load_ushort v102, v9, s[12:15], 0 offen offset:1152
    buffer_load_ushort v103, v9, s[12:15], 0 offen offset:1216
    buffer_load_ushort v104, v9, s[12:15], 0 offen offset:32
    buffer_load_ushort v105, v9, s[12:15], 0 offen offset:96
    buffer_load_ushort v106, v9, s[12:15], 0 offen offset:160
    buffer_load_ushort v107, v9, s[12:15], 0 offen offset:224
    buffer_load_ushort v108, v9, s[12:15], 0 offen offset:1056
    buffer_load_ushort v109, v9, s[12:15], 0 offen offset:1120
    buffer_load_ushort v110, v9, s[12:15], 0 offen offset:1184
    buffer_load_ushort v111, v9, s[12:15], 0 offen offset:1248
    s_lshl_b32 s70, s2, 2
    s_add_u32 s70, s70, s16
    s_lshl_b32 s70, s70, 13
    v_lshlrev_b32 v244, 7, v1
    s_mov_b32 s52, s68
    s_mov_b32 s53, s69
    s_mov_b32 s54, 0x700000
    s_mov_b32 s55, 0x20000
    s_mov_b32 s56, s62
    s_mov_b32 s57, s63
    s_mov_b32 s58, 0x700000
    s_mov_b32 s59, 0x20000
    s_mul_i32 s71, s16, 3
    s_sub_u32 s71, 13, s71
    s_sub_u32 s72, s71, 1
    s_mov_b32 s26, 0
    s_mov_b32 s27, 0xfffec000
    s_mov_b32 s28, 40960
    s_mov_b32 s19, 14
    s_barrier
    ds_read_b128 v[16:19], v2 offset:0
    ds_read_b64_tr_b16 v[32:33], v3 offset:16384
    ds_read_b64_tr_b16 v[34:35], v3 offset:18432
    ds_read_b128 v[20:23], v2 offset:2048
    ds_read_b128 v[24:27], v2 offset:4096
    ds_read_b128 v[28:31], v2 offset:6144
    ds_read_b64_tr_b16 v[36:37], v4 offset:16384
    ds_read_b64_tr_b16 v[38:39], v4 offset:18432
    ds_read_b64_tr_b16 v[40:41], v3 offset:24576
    ds_read_b64_tr_b16 v[42:43], v3 offset:26624
    ds_read_b64_tr_b16 v[44:45], v4 offset:24576
    ds_read_b64_tr_b16 v[46:47], v4 offset:26624
    ds_read_b64_tr_b16 v[48:49], v3 offset:32768
    ds_read_b64_tr_b16 v[50:51], v3 offset:34816
    ds_read_b64_tr_b16 v[52:53], v4 offset:32768
    ds_read_b64_tr_b16 v[54:55], v4 offset:34816
    s_mov_b32 s48, s60
    s_mov_b32 s49, s61
    s_mov_b32 s50, 0x200000
    s_mov_b32 s51, 0x20000
    s_lshl_b32 s40, s2, 2
    s_add_u32 s40, s40, s16
    s_lshl_b32 s40, s40, 13
    v_lshlrev_b32 v9, 7, v1
    buffer_load_dword v242, v9, s[48:51], s40 offen
    s_waitcnt lgkmcnt(13)
    v_mfma_f32_16x16x32_bf16 v[112:115], v[32:35], v[16:19], 0
    ds_read_b128 v[56:59], v2 offset:1024
    s_waitcnt lgkmcnt(13)
    v_mfma_f32_16x16x32_bf16 v[136:139], v[32:35], v[20:23], 0
    ds_read_b64_tr_b16 v[72:73], v3 offset:20480
    s_waitcnt lgkmcnt(13)
    v_mfma_f32_16x16x32_bf16 v[160:163], v[32:35], v[24:27], 0
    ds_read_b64_tr_b16 v[74:75], v3 offset:22528
    s_waitcnt lgkmcnt(13)
    v_mfma_f32_16x16x32_bf16 v[184:187], v[32:35], v[28:31], 0
    ds_read_b128 v[60:63], v2 offset:3072
    s_waitcnt lgkmcnt(12)
    v_mfma_f32_16x16x32_bf16 v[116:119], v[36:39], v[16:19], 0
    ds_read_b128 v[64:67], v2 offset:5120
    v_mfma_f32_16x16x32_bf16 v[140:143], v[36:39], v[20:23], 0
    ds_read_b128 v[68:71], v2 offset:7168
    v_mfma_f32_16x16x32_bf16 v[164:167], v[36:39], v[24:27], 0
    ds_read_b64_tr_b16 v[76:77], v4 offset:20480
    v_mfma_f32_16x16x32_bf16 v[188:191], v[36:39], v[28:31], 0
    ds_read_b64_tr_b16 v[78:79], v4 offset:22528
    s_waitcnt lgkmcnt(14)
    v_mfma_f32_16x16x32_bf16 v[120:123], v[40:43], v[16:19], 0
    ds_read_b64_tr_b16 v[80:81], v3 offset:28672
    v_mfma_f32_16x16x32_bf16 v[144:147], v[40:43], v[20:23], 0
    ds_read_b64_tr_b16 v[82:83], v3 offset:30720
    v_mfma_f32_16x16x32_bf16 v[168:171], v[40:43], v[24:27], 0
    ds_read_b64_tr_b16 v[84:85], v4 offset:28672
    v_mfma_f32_16x16x32_bf16 v[192:195], v[40:43], v[28:31], 0
    ds_read_b64_tr_b16 v[86:87], v4 offset:30720
    s_waitcnt lgkmcnt(15)
    v_mfma_f32_16x16x32_bf16 v[124:127], v[44:47], v[16:19], 0
    ds_read_b64_tr_b16 v[88:89], v3 offset:36864
    v_mfma_f32_16x16x32_bf16 v[148:151], v[44:47], v[20:23], 0
    ds_read_b64_tr_b16 v[90:91], v3 offset:38912
    v_mfma_f32_16x16x32_bf16 v[172:175], v[44:47], v[24:27], 0
    ds_read_b64_tr_b16 v[92:93], v4 offset:36864
    v_mfma_f32_16x16x32_bf16 v[196:199], v[44:47], v[28:31], 0
    ds_read_b64_tr_b16 v[94:95], v4 offset:38912
    s_add_u32 s26, s26, 40960
    s_cmp_eq_u32 s26, 122880
    s_cselect_b32 s23, s27, s28
    s_cselect_b32 s26, 0, s26
    v_add_u32 v2, s23, v2
    v_add_u32 v3, s23, v3
    v_add_u32 v4, s23, v4
    s_waitcnt lgkmcnt(15)
    v_mfma_f32_16x16x32_bf16 v[128:131], v[16:19], v[48:51], 0
    v_mfma_f32_16x16x32_bf16 v[152:155], v[20:23], v[48:51], 0
    v_mfma_f32_16x16x32_bf16 v[176:179], v[24:27], v[48:51], 0
    v_mfma_f32_16x16x32_bf16 v[200:203], v[28:31], v[48:51], 0
    v_mfma_f32_16x16x32_bf16 v[132:135], v[16:19], v[52:55], 0
    v_mfma_f32_16x16x32_bf16 v[156:159], v[20:23], v[52:55], 0
    v_mfma_f32_16x16x32_bf16 v[180:183], v[24:27], v[52:55], 0
    v_mfma_f32_16x16x32_bf16 v[204:207], v[28:31], v[52:55], 0
    s_waitcnt lgkmcnt(0)
    s_barrier
    v_mfma_f32_16x16x32_bf16 v[112:115], v[72:75], v[56:59], v[112:115]
    ds_read_b128 v[16:19], v2 offset:0
    v_mfma_f32_16x16x32_bf16 v[136:139], v[72:75], v[60:63], v[136:139]
    ds_read_b64_tr_b16 v[32:33], v3 offset:16384
    v_mfma_f32_16x16x32_bf16 v[160:163], v[72:75], v[64:67], v[160:163]
    ds_read_b64_tr_b16 v[34:35], v3 offset:18432
    v_mfma_f32_16x16x32_bf16 v[184:187], v[72:75], v[68:71], v[184:187]
    ds_read_b128 v[20:23], v2 offset:2048
    v_mfma_f32_16x16x32_bf16 v[116:119], v[76:79], v[56:59], v[116:119]
    ds_read_b128 v[24:27], v2 offset:4096
    v_mfma_f32_16x16x32_bf16 v[140:143], v[76:79], v[60:63], v[140:143]
    ds_read_b128 v[28:31], v2 offset:6144
    v_mfma_f32_16x16x32_bf16 v[164:167], v[76:79], v[64:67], v[164:167]
    ds_read_b64_tr_b16 v[36:37], v4 offset:16384
    v_mfma_f32_16x16x32_bf16 v[188:191], v[76:79], v[68:71], v[188:191]
    ds_read_b64_tr_b16 v[38:39], v4 offset:18432
    v_mfma_f32_16x16x32_bf16 v[120:123], v[80:83], v[56:59], v[120:123]
    ds_read_b64_tr_b16 v[40:41], v3 offset:24576
    v_mfma_f32_16x16x32_bf16 v[144:147], v[80:83], v[60:63], v[144:147]
    ds_read_b64_tr_b16 v[42:43], v3 offset:26624
    v_mfma_f32_16x16x32_bf16 v[168:171], v[80:83], v[64:67], v[168:171]
    ds_read_b64_tr_b16 v[44:45], v4 offset:24576
    v_mfma_f32_16x16x32_bf16 v[192:195], v[80:83], v[68:71], v[192:195]
    ds_read_b64_tr_b16 v[46:47], v4 offset:26624
    v_mfma_f32_16x16x32_bf16 v[124:127], v[84:87], v[56:59], v[124:127]
    ds_read_b64_tr_b16 v[48:49], v3 offset:32768
    v_mfma_f32_16x16x32_bf16 v[148:151], v[84:87], v[60:63], v[148:151]
    ds_read_b64_tr_b16 v[50:51], v3 offset:34816
    v_mfma_f32_16x16x32_bf16 v[172:175], v[84:87], v[64:67], v[172:175]
    ds_read_b64_tr_b16 v[52:53], v4 offset:32768
    v_mfma_f32_16x16x32_bf16 v[196:199], v[84:87], v[68:71], v[196:199]
    ds_read_b64_tr_b16 v[54:55], v4 offset:34816
    v_mfma_f32_16x16x32_bf16 v[128:131], v[56:59], v[88:91], v[128:131]
    v_mfma_f32_16x16x32_bf16 v[152:155], v[60:63], v[88:91], v[152:155]
    v_mfma_f32_16x16x32_bf16 v[176:179], v[64:67], v[88:91], v[176:179]
    v_mfma_f32_16x16x32_bf16 v[200:203], v[68:71], v[88:91], v[200:203]
    v_mfma_f32_16x16x32_bf16 v[132:135], v[56:59], v[92:95], v[132:135]
    v_mfma_f32_16x16x32_bf16 v[156:159], v[60:63], v[92:95], v[156:159]
    v_mfma_f32_16x16x32_bf16 v[180:183], v[64:67], v[92:95], v[180:183]
    v_mfma_f32_16x16x32_bf16 v[204:207], v[68:71], v[92:95], v[204:207]
K1_cloop:
    s_cmp_lg_u32 s19, s71
    s_cbranch_scc1 K1_noonce0
    buffer_load_dword v243, v244, s[52:55], s70 offen
K1_noonce0:
    s_cmp_lg_u32 s19, s72
    s_cbranch_scc1 K1_noonce1
    buffer_load_dword v240, v244, s[56:59], s70 offen
K1_noonce1:
    s_waitcnt lgkmcnt(13)
    v_mfma_f32_16x16x32_bf16 v[112:115], v[32:35], v[16:19], v[112:115]
    ds_read_b128 v[56:59], v2 offset:1024
    s_waitcnt lgkmcnt(13)
    v_mfma_f32_16x16x32_bf16 v[136:139], v[32:35], v[20:23], v[136:139]
    ds_read_b64_tr_b16 v[72:73], v3 offset:20480
    s_waitcnt lgkmcnt(13)
    v_mfma_f32_16x16x32_bf16 v[160:163], v[32:35], v[24:27], v[160:163]
    ds_read_b64_tr_b16 v[74:75], v3 offset:22528
    s_waitcnt lgkmcnt(13)
    v_mfma_f32_16x16x32_bf16 v[184:187], v[32:35], v[28:31], v[184:187]
    ds_read_b128 v[60:63], v2 offset:3072
    s_waitcnt lgkmcnt(12)
    v_mfma_f32_16x16x32_bf16 v[116:119], v[36:39], v[16:19], v[116:119]
    ds_read_b128 v[64:67], v2 offset:5120
    v_mfma_f32_16x16x32_bf16 v[140:143], v[36:39], v[20:23], v[140:143]
    ds_read_b128 v[68:71], v2 offset:7168
    v_mfma_f32_16x16x32_bf16 v[164:167], v[36:39], v[24:27], v[164:167]
    ds_read_b64_tr_b16 v[76:77], v4 offset:20480
    v_mfma_f32_16x16x32_bf16 v[188:191], v[36:39], v[28:31], v[188:191]
    ds_read_b64_tr_b16 v[78:79], v4 offset:22528
    s_waitcnt lgkmcnt(14)
    v_mfma_f32_16x16x32_bf16 v[120:123], v[40:43], v[16:19], v[120:123]
    ds_read_b64_tr_b16 v[80:81], v3 offset:28672
    v_mfma_f32_16x16x32_bf16 v[144:147], v[40:43], v[20:23], v[144:147]
    ds_read_b64_tr_b16 v[82:83], v3 offset:30720
    v_mfma_f32_16x16x32_bf16 v[168:171], v[40:43], v[24:27], v[168:171]
    ds_read_b64_tr_b16 v[84:85], v4 offset:28672
    v_mfma_f32_16x16x32_bf16 v[192:195], v[40:43], v[28:31], v[192:195]
    ds_read_b64_tr_b16 v[86:87], v4 offset:30720
    s_waitcnt lgkmcnt(15)
    v_mfma_f32_16x16x32_bf16 v[124:127], v[44:47], v[16:19], v[124:127]
    ds_read_b64_tr_b16 v[88:89], v3 offset:36864
    v_mfma_f32_16x16x32_bf16 v[148:151], v[44:47], v[20:23], v[148:151]
    ds_read_b64_tr_b16 v[90:91], v3 offset:38912
    v_mfma_f32_16x16x32_bf16 v[172:175], v[44:47], v[24:27], v[172:175]
    ds_read_b64_tr_b16 v[92:93], v4 offset:36864
    v_mfma_f32_16x16x32_bf16 v[196:199], v[44:47], v[28:31], v[196:199]
    ds_read_b64_tr_b16 v[94:95], v4 offset:38912
    s_add_u32 s26, s26, 40960
    s_cmp_eq_u32 s26, 122880
    s_cselect_b32 s23, s27, s28
    s_cselect_b32 s26, 0, s26
    v_add_u32 v2, s23, v2
    v_add_u32 v3, s23, v3
    v_add_u32 v4, s23, v4
    s_waitcnt lgkmcnt(15)
    v_mfma_f32_16x16x32_bf16 v[128:131], v[16:19], v[48:51], v[128:131]
    v_mfma_f32_16x16x32_bf16 v[152:155], v[20:23], v[48:51], v[152:155]
    v_mfma_f32_16x16x32_bf16 v[176:179], v[24:27], v[48:51], v[176:179]
    v_mfma_f32_16x16x32_bf16 v[200:203], v[28:31], v[48:51], v[200:203]
    v_mfma_f32_16x16x32_bf16 v[132:135], v[16:19], v[52:55], v[132:135]
    v_mfma_f32_16x16x32_bf16 v[156:159], v[20:23], v[52:55], v[156:159]
    v_mfma_f32_16x16x32_bf16 v[180:183], v[24:27], v[52:55], v[180:183]
    v_mfma_f32_16x16x32_bf16 v[204:207], v[28:31], v[52:55], v[204:207]
    s_sub_u32 s19, s19, 1
    s_waitcnt lgkmcnt(0)
    s_barrier
    v_mfma_f32_16x16x32_bf16 v[112:115], v[72:75], v[56:59], v[112:115]
    ds_read_b128 v[16:19], v2 offset:0
    v_mfma_f32_16x16x32_bf16 v[136:139], v[72:75], v[60:63], v[136:139]
    ds_read_b64_tr_b16 v[32:33], v3 offset:16384
    v_mfma_f32_16x16x32_bf16 v[160:163], v[72:75], v[64:67], v[160:163]
    ds_read_b64_tr_b16 v[34:35], v3 offset:18432
    v_mfma_f32_16x16x32_bf16 v[184:187], v[72:75], v[68:71], v[184:187]
    ds_read_b128 v[20:23], v2 offset:2048
    v_mfma_f32_16x16x32_bf16 v[116:119], v[76:79], v[56:59], v[116:119]
    ds_read_b128 v[24:27], v2 offset:4096
    v_mfma_f32_16x16x32_bf16 v[140:143], v[76:79], v[60:63], v[140:143]
    ds_read_b128 v[28:31], v2 offset:6144
    v_mfma_f32_16x16x32_bf16 v[164:167], v[76:79], v[64:67], v[164:167]
    ds_read_b64_tr_b16 v[36:37], v4 offset:16384
    v_mfma_f32_16x16x32_bf16 v[188:191], v[76:79], v[68:71], v[188:191]
    ds_read_b64_tr_b16 v[38:39], v4 offset:18432
    v_mfma_f32_16x16x32_bf16 v[120:123], v[80:83], v[56:59], v[120:123]
    ds_read_b64_tr_b16 v[40:41], v3 offset:24576
    v_mfma_f32_16x16x32_bf16 v[144:147], v[80:83], v[60:63], v[144:147]
    ds_read_b64_tr_b16 v[42:43], v3 offset:26624
    v_mfma_f32_16x16x32_bf16 v[168:171], v[80:83], v[64:67], v[168:171]
    ds_read_b64_tr_b16 v[44:45], v4 offset:24576
    v_mfma_f32_16x16x32_bf16 v[192:195], v[80:83], v[68:71], v[192:195]
    ds_read_b64_tr_b16 v[46:47], v4 offset:26624
    v_mfma_f32_16x16x32_bf16 v[124:127], v[84:87], v[56:59], v[124:127]
    ds_read_b64_tr_b16 v[48:49], v3 offset:32768
    v_mfma_f32_16x16x32_bf16 v[148:151], v[84:87], v[60:63], v[148:151]
    ds_read_b64_tr_b16 v[50:51], v3 offset:34816
    v_mfma_f32_16x16x32_bf16 v[172:175], v[84:87], v[64:67], v[172:175]
    ds_read_b64_tr_b16 v[52:53], v4 offset:32768
    v_mfma_f32_16x16x32_bf16 v[196:199], v[84:87], v[68:71], v[196:199]
    ds_read_b64_tr_b16 v[54:55], v4 offset:34816
    v_mfma_f32_16x16x32_bf16 v[128:131], v[56:59], v[88:91], v[128:131]
    v_mfma_f32_16x16x32_bf16 v[152:155], v[60:63], v[88:91], v[152:155]
    v_mfma_f32_16x16x32_bf16 v[176:179], v[64:67], v[88:91], v[176:179]
    v_mfma_f32_16x16x32_bf16 v[200:203], v[68:71], v[88:91], v[200:203]
    v_mfma_f32_16x16x32_bf16 v[132:135], v[56:59], v[92:95], v[132:135]
    v_mfma_f32_16x16x32_bf16 v[156:159], v[60:63], v[92:95], v[156:159]
    v_mfma_f32_16x16x32_bf16 v[180:183], v[64:67], v[92:95], v[180:183]
    v_mfma_f32_16x16x32_bf16 v[204:207], v[68:71], v[92:95], v[204:207]
    s_cmp_lg_u32 s19, 0
    s_cbranch_scc1 K1_cloop
    s_waitcnt lgkmcnt(13)
    v_mfma_f32_16x16x32_bf16 v[112:115], v[32:35], v[16:19], v[112:115]
    ds_read_b128 v[56:59], v2 offset:1024
    s_waitcnt lgkmcnt(13)
    v_mfma_f32_16x16x32_bf16 v[136:139], v[32:35], v[20:23], v[136:139]
    ds_read_b64_tr_b16 v[72:73], v3 offset:20480
    s_waitcnt lgkmcnt(13)
    v_mfma_f32_16x16x32_bf16 v[160:163], v[32:35], v[24:27], v[160:163]
    ds_read_b64_tr_b16 v[74:75], v3 offset:22528
    s_waitcnt lgkmcnt(13)
    v_mfma_f32_16x16x32_bf16 v[184:187], v[32:35], v[28:31], v[184:187]
    ds_read_b128 v[60:63], v2 offset:3072
    s_waitcnt lgkmcnt(12)
    v_mfma_f32_16x16x32_bf16 v[116:119], v[36:39], v[16:19], v[116:119]
    ds_read_b128 v[64:67], v2 offset:5120
    v_mfma_f32_16x16x32_bf16 v[140:143], v[36:39], v[20:23], v[140:143]
    ds_read_b128 v[68:71], v2 offset:7168
    v_mfma_f32_16x16x32_bf16 v[164:167], v[36:39], v[24:27], v[164:167]
    ds_read_b64_tr_b16 v[76:77], v4 offset:20480
    v_mfma_f32_16x16x32_bf16 v[188:191], v[36:39], v[28:31], v[188:191]
    ds_read_b64_tr_b16 v[78:79], v4 offset:22528
    s_waitcnt lgkmcnt(14)
    v_mfma_f32_16x16x32_bf16 v[120:123], v[40:43], v[16:19], v[120:123]
    ds_read_b64_tr_b16 v[80:81], v3 offset:28672
    v_mfma_f32_16x16x32_bf16 v[144:147], v[40:43], v[20:23], v[144:147]
    ds_read_b64_tr_b16 v[82:83], v3 offset:30720
    v_mfma_f32_16x16x32_bf16 v[168:171], v[40:43], v[24:27], v[168:171]
    ds_read_b64_tr_b16 v[84:85], v4 offset:28672
    v_mfma_f32_16x16x32_bf16 v[192:195], v[40:43], v[28:31], v[192:195]
    ds_read_b64_tr_b16 v[86:87], v4 offset:30720
    s_waitcnt lgkmcnt(15)
    v_mfma_f32_16x16x32_bf16 v[124:127], v[44:47], v[16:19], v[124:127]
    ds_read_b64_tr_b16 v[88:89], v3 offset:36864
    v_mfma_f32_16x16x32_bf16 v[148:151], v[44:47], v[20:23], v[148:151]
    ds_read_b64_tr_b16 v[90:91], v3 offset:38912
    v_mfma_f32_16x16x32_bf16 v[172:175], v[44:47], v[24:27], v[172:175]
    ds_read_b64_tr_b16 v[92:93], v4 offset:36864
    v_mfma_f32_16x16x32_bf16 v[196:199], v[44:47], v[28:31], v[196:199]
    ds_read_b64_tr_b16 v[94:95], v4 offset:38912
    s_waitcnt lgkmcnt(15)
    v_mfma_f32_16x16x32_bf16 v[128:131], v[16:19], v[48:51], v[128:131]
    v_mfma_f32_16x16x32_bf16 v[152:155], v[20:23], v[48:51], v[152:155]
    v_mfma_f32_16x16x32_bf16 v[176:179], v[24:27], v[48:51], v[176:179]
    v_mfma_f32_16x16x32_bf16 v[200:203], v[28:31], v[48:51], v[200:203]
    v_mfma_f32_16x16x32_bf16 v[132:135], v[16:19], v[52:55], v[132:135]
    v_mfma_f32_16x16x32_bf16 v[156:159], v[20:23], v[52:55], v[156:159]
    v_mfma_f32_16x16x32_bf16 v[180:183], v[24:27], v[52:55], v[180:183]
    v_mfma_f32_16x16x32_bf16 v[204:207], v[28:31], v[52:55], v[204:207]
    s_waitcnt lgkmcnt(13)
    v_mfma_f32_16x16x32_bf16 v[112:115], v[72:75], v[56:59], v[112:115]
    s_waitcnt lgkmcnt(12)
    v_mfma_f32_16x16x32_bf16 v[136:139], v[72:75], v[60:63], v[136:139]
    s_waitcnt lgkmcnt(11)
    v_mfma_f32_16x16x32_bf16 v[160:163], v[72:75], v[64:67], v[160:163]
    s_waitcnt lgkmcnt(10)
    v_mfma_f32_16x16x32_bf16 v[184:187], v[72:75], v[68:71], v[184:187]
    s_waitcnt lgkmcnt(8)
    v_mfma_f32_16x16x32_bf16 v[116:119], v[76:79], v[56:59], v[116:119]
    v_mfma_f32_16x16x32_bf16 v[140:143], v[76:79], v[60:63], v[140:143]
    v_mfma_f32_16x16x32_bf16 v[164:167], v[76:79], v[64:67], v[164:167]
    v_mfma_f32_16x16x32_bf16 v[188:191], v[76:79], v[68:71], v[188:191]
    s_waitcnt lgkmcnt(6)
    v_mfma_f32_16x16x32_bf16 v[120:123], v[80:83], v[56:59], v[120:123]
    v_mfma_f32_16x16x32_bf16 v[144:147], v[80:83], v[60:63], v[144:147]
    v_mfma_f32_16x16x32_bf16 v[168:171], v[80:83], v[64:67], v[168:171]
    v_mfma_f32_16x16x32_bf16 v[192:195], v[80:83], v[68:71], v[192:195]
    s_waitcnt lgkmcnt(4)
    v_mfma_f32_16x16x32_bf16 v[124:127], v[84:87], v[56:59], v[124:127]
    v_mfma_f32_16x16x32_bf16 v[148:151], v[84:87], v[60:63], v[148:151]
    v_mfma_f32_16x16x32_bf16 v[172:175], v[84:87], v[64:67], v[172:175]
    v_mfma_f32_16x16x32_bf16 v[196:199], v[84:87], v[68:71], v[196:199]
    s_waitcnt lgkmcnt(2)
    v_mfma_f32_16x16x32_bf16 v[128:131], v[56:59], v[88:91], v[128:131]
    v_mfma_f32_16x16x32_bf16 v[152:155], v[60:63], v[88:91], v[152:155]
    v_mfma_f32_16x16x32_bf16 v[176:179], v[64:67], v[88:91], v[176:179]
    v_mfma_f32_16x16x32_bf16 v[200:203], v[68:71], v[88:91], v[200:203]
    s_waitcnt lgkmcnt(0)
    v_mfma_f32_16x16x32_bf16 v[132:135], v[56:59], v[92:95], v[132:135]
    v_mfma_f32_16x16x32_bf16 v[156:159], v[60:63], v[92:95], v[156:159]
    v_mfma_f32_16x16x32_bf16 v[180:183], v[64:67], v[92:95], v[180:183]
    v_mfma_f32_16x16x32_bf16 v[204:207], v[68:71], v[92:95], v[204:207]
    v_cvt_pk_bf16_f32 v16, v120, v121
    v_cvt_pk_bf16_f32 v17, v122, v123
    v_cvt_pk_bf16_f32 v18, v124, v125
    v_cvt_pk_bf16_f32 v19, v126, v127
    v_cvt_pk_bf16_f32 v20, v144, v145
    v_cvt_pk_bf16_f32 v21, v146, v147
    v_cvt_pk_bf16_f32 v22, v148, v149
    v_cvt_pk_bf16_f32 v23, v150, v151
    v_cvt_pk_bf16_f32 v24, v168, v169
    v_cvt_pk_bf16_f32 v25, v170, v171
    v_cvt_pk_bf16_f32 v26, v172, v173
    v_cvt_pk_bf16_f32 v27, v174, v175
    v_cvt_pk_bf16_f32 v28, v192, v193
    v_cvt_pk_bf16_f32 v29, v194, v195
    v_cvt_pk_bf16_f32 v30, v196, v197
    v_cvt_pk_bf16_f32 v31, v198, v199
    v_cvt_pk_bf16_f32 v32, v128, v129
    v_cvt_pk_bf16_f32 v33, v130, v131
    v_cvt_pk_bf16_f32 v34, v152, v153
    v_cvt_pk_bf16_f32 v35, v154, v155
    v_cvt_pk_bf16_f32 v36, v132, v133
    v_cvt_pk_bf16_f32 v37, v134, v135
    v_cvt_pk_bf16_f32 v38, v156, v157
    v_cvt_pk_bf16_f32 v39, v158, v159
    v_cvt_pk_bf16_f32 v40, v176, v177
    v_cvt_pk_bf16_f32 v41, v178, v179
    v_cvt_pk_bf16_f32 v42, v200, v201
    v_cvt_pk_bf16_f32 v43, v202, v203
    v_cvt_pk_bf16_f32 v44, v180, v181
    v_cvt_pk_bf16_f32 v45, v182, v183
    v_cvt_pk_bf16_f32 v46, v204, v205
    v_cvt_pk_bf16_f32 v47, v206, v207
    v_lshlrev_b32 v9, 4, v1
    s_lshl_b32 s41, s16, 13
    s_add_u32 s41, s41, 122880
    v_add_u32 v9, s41, v9
    ds_write_b128 v9, v[16:19] offset:0
    ds_write_b128 v9, v[20:23] offset:1024
    ds_write_b128 v9, v[24:27] offset:2048
    ds_write_b128 v9, v[28:31] offset:3072
    ds_write_b128 v9, v[32:35] offset:4096
    ds_write_b128 v9, v[36:39] offset:5120
    ds_write_b128 v9, v[40:43] offset:6144
    ds_write_b128 v9, v[44:47] offset:7168
    v_cvt_pk_bf16_f32 v48, v112, v113
    v_cvt_pk_bf16_f32 v49, v114, v115
    v_cvt_pk_bf16_f32 v50, v116, v117
    v_cvt_pk_bf16_f32 v51, v118, v119
    v_cvt_pk_bf16_f32 v52, v136, v137
    v_cvt_pk_bf16_f32 v53, v138, v139
    v_cvt_pk_bf16_f32 v54, v140, v141
    v_cvt_pk_bf16_f32 v55, v142, v143
    v_cvt_pk_bf16_f32 v56, v160, v161
    v_cvt_pk_bf16_f32 v57, v162, v163
    v_cvt_pk_bf16_f32 v58, v164, v165
    v_cvt_pk_bf16_f32 v59, v166, v167
    v_cvt_pk_bf16_f32 v60, v184, v185
    v_cvt_pk_bf16_f32 v61, v186, v187
    v_cvt_pk_bf16_f32 v62, v188, v189
    v_cvt_pk_bf16_f32 v63, v190, v191
    s_waitcnt lgkmcnt(0)
    s_barrier
    s_waitcnt vmcnt(0)
    v_lshl_or_b32 v96, v97, 16, v96
    v_lshl_or_b32 v97, v99, 16, v98
    v_lshl_or_b32 v98, v101, 16, v100
    v_lshl_or_b32 v99, v103, 16, v102
    v_lshl_or_b32 v100, v105, 16, v104
    v_lshl_or_b32 v101, v107, 16, v106
    v_lshl_or_b32 v102, v109, 16, v108
    v_lshl_or_b32 v103, v111, 16, v110
    s_lshr_b32 s31, s2, 4
    s_mov_b32 s8, s60
    s_mov_b32 s9, s61
    s_mov_b32 s10, 0x200000
    s_mov_b32 s11, 0x20000
    v_lshrrev_b32 v7, 3, v1
    v_lshlrev_b32 v7, 11, v7
    v_bfe_u32 v8, v1, 4, 2
    v_lshlrev_b32 v8, 1, v8
    v_and_b32 v9, 7, v1
    v_xor_b32 v8, v8, v9
    v_lshl_add_u32 v7, v8, 4, v7
    s_lshl_b32 s43, s16, 15
    s_lshl_b32 s41, s31, 7
    s_add_u32 s43, s43, s41
    v_add_u32 v7, s43, v7
    v_add_u32 v8, 15360, v7
    s_lshl_b32 s41, s16, 11
    s_mov_b32 s43, 524288
    s_add_u32 m0, s41, 32768
    s_nop 0
    buffer_load_dwordx4 v7, s[8:11], s43 offen lds
    buffer_load_dwordx4 v8, s[8:11], s43 offen offset:1024 lds
    s_add_u32 s43, s43, 131072
    s_add_u32 m0, s41, 40960
    s_nop 0
    buffer_load_dwordx4 v7, s[8:11], s43 offen lds
    buffer_load_dwordx4 v8, s[8:11], s43 offen offset:1024 lds
    s_add_u32 s43, s43, 131072
    s_add_u32 m0, s41, 49152
    s_nop 0
    buffer_load_dwordx4 v7, s[8:11], s43 offen lds
    buffer_load_dwordx4 v8, s[8:11], s43 offen offset:1024 lds
    s_add_u32 s43, s43, 131072
    s_add_u32 m0, s41, 57344
    s_nop 0
    buffer_load_dwordx4 v7, s[8:11], s43 offen lds
    buffer_load_dwordx4 v8, s[8:11], s43 offen offset:1024 lds
    s_add_u32 s43, s43, 131072
    s_add_u32 m0, s41, 65536
    s_nop 0
    buffer_load_dwordx4 v7, s[8:11], s43 offen lds
    buffer_load_dwordx4 v8, s[8:11], s43 offen offset:1024 lds
    s_add_u32 s43, s43, 131072
    s_add_u32 m0, s41, 73728
    s_nop 0
    buffer_load_dwordx4 v7, s[8:11], s43 offen lds
    buffer_load_dwordx4 v8, s[8:11], s43 offen offset:1024 lds
    s_add_u32 s43, s43, 131072
    s_add_u32 m0, s41, 81920
    s_nop 0
    buffer_load_dwordx4 v7, s[8:11], s43 offen lds
    buffer_load_dwordx4 v8, s[8:11], s43 offen offset:1024 lds
    s_add_u32 s43, s43, 131072
    s_add_u32 m0, s41, 90112
    s_nop 0
    buffer_load_dwordx4 v7, s[8:11], s43 offen lds
    buffer_load_dwordx4 v8, s[8:11], s43 offen offset:1024 lds
    s_add_u32 s43, s43, 131072
    s_add_u32 m0, s41, 98304
    s_nop 0
    buffer_load_dwordx4 v7, s[8:11], s43 offen lds
    buffer_load_dwordx4 v8, s[8:11], s43 offen offset:1024 lds
    s_add_u32 s43, s43, 131072
    s_add_u32 m0, s41, 106496
    s_nop 0
    buffer_load_dwordx4 v7, s[8:11], s43 offen lds
    buffer_load_dwordx4 v8, s[8:11], s43 offen offset:1024 lds
    s_add_u32 s43, s43, 131072
    s_add_u32 m0, s41, 114688
    s_nop 0
    buffer_load_dwordx4 v7, s[8:11], s43 offen lds
    buffer_load_dwordx4 v8, s[8:11], s43 offen offset:1024 lds
    s_lshl_b32 s41, s16, 2
    s_add_u32 s41, s41, 155648
    v_mov_b32 v14, s41
    s_mov_b32 s77, 0x100000
KA_qw:
    ds_read_b32 v15, v14
    s_waitcnt lgkmcnt(0)
    v_readfirstlane_b32 s78, v15
    s_nop 3
    s_cmp_eq_u32 s78, 1
    s_cbranch_scc1 KA_qw_done
    s_sleep 2
    s_sub_u32 s77, s77, 1
    s_cmp_lg_u32 s77, 0
    s_cbranch_scc1 KA_qw
KA_qw_done:
    s_mov_b32 s46, 0x3fb8aa3b
    s_mov_b32 s47, 0x3fb8aa3b
    v_mfma_f32_16x16x32_bf16 v[112:115], v[96:99], v[48:51], 0
    v_mfma_f32_16x16x32_bf16 v[116:119], v[100:103], v[48:51], 0
    v_mfma_f32_16x16x32_bf16 v[120:123], v[96:99], v[52:55], 0
    v_mfma_f32_16x16x32_bf16 v[124:127], v[100:103], v[52:55], 0
    v_mfma_f32_16x16x32_bf16 v[128:131], v[96:99], v[56:59], 0
    v_mfma_f32_16x16x32_bf16 v[132:135], v[100:103], v[56:59], 0
    v_mfma_f32_16x16x32_bf16 v[136:139], v[96:99], v[60:63], 0
    v_mfma_f32_16x16x32_bf16 v[140:143], v[100:103], v[60:63], 0
    s_nop 0
    v_max3_f32 v176, v112, v113, v114
    v_min3_f32 v184, v112, v113, v114
    v_max3_f32 v178, v120, v121, v122
    v_min3_f32 v186, v120, v121, v122
    v_max3_f32 v180, v128, v129, v130
    v_min3_f32 v188, v128, v129, v130
    v_max3_f32 v182, v136, v137, v138
    v_min3_f32 v190, v136, v137, v138
    v_max3_f32 v176, v176, v115, v116
    v_min3_f32 v184, v184, v115, v116
    v_max3_f32 v178, v178, v123, v124
    v_min3_f32 v186, v186, v123, v124
    v_max3_f32 v180, v180, v131, v132
    v_min3_f32 v188, v188, v131, v132
    v_max3_f32 v182, v182, v139, v140
    v_min3_f32 v190, v190, v139, v140
    v_max3_f32 v176, v176, v117, v118
    v_min3_f32 v184, v184, v117, v118
    v_max3_f32 v178, v178, v125, v126
    v_min3_f32 v186, v186, v125, v126
    v_max3_f32 v180, v180, v133, v134
    v_min3_f32 v188, v188, v133, v134
    v_max3_f32 v182, v182, v141, v142
    v_min3_f32 v190, v190, v141, v142
    v_max_f32 v176, v176, v119
    v_min_f32 v184, v184, v119
    v_max_f32 v178, v178, v127
    v_min_f32 v186, v186, v127
    v_max_f32 v180, v180, v135
    v_min_f32 v188, v188, v135
    v_max_f32 v182, v182, v143
    v_min_f32 v190, v190, v143
    v_permlane32_swap_b32 v176, v178
    v_permlane32_swap_b32 v184, v186
    v_permlane32_swap_b32 v180, v182
    v_permlane32_swap_b32 v188, v190
    v_max_f32 v176, v176, v178
    v_min_f32 v184, v184, v186
    v_max_f32 v180, v180, v182
    v_min_f32 v188, v188, v190
    s_nop 0
    v_permlane16_swap_b32 v176, v180
    v_permlane16_swap_b32 v184, v188
    v_max_f32 v176, v176, v180
    v_min_f32 v184, v184, v188
    v_mov_b32 v180, v176
    v_mov_b32 v188, v184
    s_nop 0
    v_permlane16_swap_b32 v176, v180
    v_permlane16_swap_b32 v184, v188
    v_mov_b32 v178, v176
    v_mov_b32 v186, v184
    v_mov_b32 v182, v180
    v_mov_b32 v190, v188
    v_permlane32_swap_b32 v176, v178
    v_permlane32_swap_b32 v184, v186
    v_permlane32_swap_b32 v180, v182
    v_permlane32_swap_b32 v188, v190
    v_mul_f32 v176, s46, v176
    v_mul_f32 v184, s46, v184
    v_mul_f32 v178, s46, v178
    v_mul_f32 v186, s46, v186
    v_mul_f32 v180, s46, v180
    v_mul_f32 v188, s46, v188
    v_mul_f32 v182, s46, v182
    v_mul_f32 v190, s46, v190
    v_pk_fma_f32 v[144:145], v[112:113], s[46:47], v[176:177] op_sel_hi:[1,1,0] neg_lo:[0,0,1] neg_hi:[0,0,1]
    v_pk_fma_f32 v[112:113], v[112:113], s[46:47], v[184:185] op_sel_hi:[1,1,0] neg_lo:[1,0,0] neg_hi:[1,0,0]
    v_pk_fma_f32 v[146:147], v[114:115], s[46:47], v[176:177] op_sel_hi:[1,1,0] neg_lo:[0,0,1] neg_hi:[0,0,1]
    v_pk_fma_f32 v[114:115], v[114:115], s[46:47], v[184:185] op_sel_hi:[1,1,0] neg_lo:[1,0,0] neg_hi:[1,0,0]
    v_pk_fma_f32 v[148:149], v[116:117], s[46:47], v[176:177] op_sel_hi:[1,1,0] neg_lo:[0,0,1] neg_hi:[0,0,1]
    v_pk_fma_f32 v[116:117], v[116:117], s[46:47], v[184:185] op_sel_hi:[1,1,0] neg_lo:[1,0,0] neg_hi:[1,0,0]
    v_pk_fma_f32 v[150:151], v[118:119], s[46:47], v[176:177] op_sel_hi:[1,1,0] neg_lo:[0,0,1] neg_hi:[0,0,1]
    v_pk_fma_f32 v[118:119], v[118:119], s[46:47], v[184:185] op_sel_hi:[1,1,0] neg_lo:[1,0,0] neg_hi:[1,0,0]
    v_pk_fma_f32 v[152:153], v[120:121], s[46:47], v[178:179] op_sel_hi:[1,1,0] neg_lo:[0,0,1] neg_hi:[0,0,1]
    v_pk_fma_f32 v[120:121], v[120:121], s[46:47], v[186:187] op_sel_hi:[1,1,0] neg_lo:[1,0,0] neg_hi:[1,0,0]
    v_pk_fma_f32 v[154:155], v[122:123], s[46:47], v[178:179] op_sel_hi:[1,1,0] neg_lo:[0,0,1] neg_hi:[0,0,1]
    v_pk_fma_f32 v[122:123], v[122:123], s[46:47], v[186:187] op_sel_hi:[1,1,0] neg_lo:[1,0,0] neg_hi:[1,0,0]
    v_pk_fma_f32 v[156:157], v[124:125], s[46:47], v[178:179] op_sel_hi:[1,1,0] neg_lo:[0,0,1] neg_hi:[0,0,1]
    v_pk_fma_f32 v[124:125], v[124:125], s[46:47], v[186:187] op_sel_hi:[1,1,0] neg_lo:[1,0,0] neg_hi:[1,0,0]
    v_pk_fma_f32 v[158:159], v[126:127], s[46:47], v[178:179] op_sel_hi:[1,1,0] neg_lo:[0,0,1] neg_hi:[0,0,1]
    v_pk_fma_f32 v[126:127], v[126:127], s[46:47], v[186:187] op_sel_hi:[1,1,0] neg_lo:[1,0,0] neg_hi:[1,0,0]
    v_pk_fma_f32 v[160:161], v[128:129], s[46:47], v[180:181] op_sel_hi:[1,1,0] neg_lo:[0,0,1] neg_hi:[0,0,1]
    v_pk_fma_f32 v[128:129], v[128:129], s[46:47], v[188:189] op_sel_hi:[1,1,0] neg_lo:[1,0,0] neg_hi:[1,0,0]
    v_pk_fma_f32 v[162:163], v[130:131], s[46:47], v[180:181] op_sel_hi:[1,1,0] neg_lo:[0,0,1] neg_hi:[0,0,1]
    v_pk_fma_f32 v[130:131], v[130:131], s[46:47], v[188:189] op_sel_hi:[1,1,0] neg_lo:[1,0,0] neg_hi:[1,0,0]
    v_pk_fma_f32 v[164:165], v[132:133], s[46:47], v[180:181] op_sel_hi:[1,1,0] neg_lo:[0,0,1] neg_hi:[0,0,1]
    v_pk_fma_f32 v[132:133], v[132:133], s[46:47], v[188:189] op_sel_hi:[1,1,0] neg_lo:[1,0,0] neg_hi:[1,0,0]
    v_pk_fma_f32 v[166:167], v[134:135], s[46:47], v[180:181] op_sel_hi:[1,1,0] neg_lo:[0,0,1] neg_hi:[0,0,1]
    v_pk_fma_f32 v[134:135], v[134:135], s[46:47], v[188:189] op_sel_hi:[1,1,0] neg_lo:[1,0,0] neg_hi:[1,0,0]
    v_pk_fma_f32 v[168:169], v[136:137], s[46:47], v[182:183] op_sel_hi:[1,1,0] neg_lo:[0,0,1] neg_hi:[0,0,1]
    v_pk_fma_f32 v[136:137], v[136:137], s[46:47], v[190:191] op_sel_hi:[1,1,0] neg_lo:[1,0,0] neg_hi:[1,0,0]
    v_pk_fma_f32 v[170:171], v[138:139], s[46:47], v[182:183] op_sel_hi:[1,1,0] neg_lo:[0,0,1] neg_hi:[0,0,1]
    v_pk_fma_f32 v[138:139], v[138:139], s[46:47], v[190:191] op_sel_hi:[1,1,0] neg_lo:[1,0,0] neg_hi:[1,0,0]
    v_pk_fma_f32 v[172:173], v[140:141], s[46:47], v[182:183] op_sel_hi:[1,1,0] neg_lo:[0,0,1] neg_hi:[0,0,1]
    v_pk_fma_f32 v[140:141], v[140:141], s[46:47], v[190:191] op_sel_hi:[1,1,0] neg_lo:[1,0,0] neg_hi:[1,0,0]
    v_pk_fma_f32 v[174:175], v[142:143], s[46:47], v[182:183] op_sel_hi:[1,1,0] neg_lo:[0,0,1] neg_hi:[0,0,1]
    v_pk_fma_f32 v[142:143], v[142:143], s[46:47], v[190:191] op_sel_hi:[1,1,0] neg_lo:[1,0,0] neg_hi:[1,0,0]
    v_exp_f32 v144, v144
    v_exp_f32 v112, v112
    v_exp_f32 v145, v145
    v_exp_f32 v113, v113
    v_exp_f32 v146, v146
    v_exp_f32 v114, v114
    v_exp_f32 v147, v147
    v_exp_f32 v115, v115
    v_exp_f32 v148, v148
    v_exp_f32 v116, v116
    v_exp_f32 v149, v149
    v_exp_f32 v117, v117
    v_exp_f32 v150, v150
    v_exp_f32 v118, v118
    v_exp_f32 v151, v151
    v_exp_f32 v119, v119
    v_exp_f32 v152, v152
    v_exp_f32 v120, v120
    v_exp_f32 v153, v153
    v_exp_f32 v121, v121
    v_exp_f32 v154, v154
    v_exp_f32 v122, v122
    v_exp_f32 v155, v155
    v_exp_f32 v123, v123
    v_exp_f32 v156, v156
    v_exp_f32 v124, v124
    v_exp_f32 v157, v157
    v_exp_f32 v125, v125
    v_exp_f32 v158, v158
    v_exp_f32 v126, v126
    v_exp_f32 v159, v159
    v_exp_f32 v127, v127
    v_exp_f32 v160, v160
    v_exp_f32 v128, v128
    v_exp_f32 v161, v161
    v_exp_f32 v129, v129
    v_exp_f32 v162, v162
    v_exp_f32 v130, v130
    v_exp_f32 v163, v163
    v_exp_f32 v131, v131
    v_exp_f32 v164, v164
    v_exp_f32 v132, v132
    v_exp_f32 v165, v165
    v_exp_f32 v133, v133
    v_exp_f32 v166, v166
    v_exp_f32 v134, v134
    v_exp_f32 v167, v167
    v_exp_f32 v135, v135
    v_exp_f32 v168, v168
    v_exp_f32 v136, v136
    v_exp_f32 v169, v169
    v_exp_f32 v137, v137
    v_exp_f32 v170, v170
    v_exp_f32 v138, v138
    v_exp_f32 v171, v171
    v_exp_f32 v139, v139
    v_exp_f32 v172, v172
    v_exp_f32 v140, v140
    v_exp_f32 v173, v173
    v_exp_f32 v141, v141
    v_exp_f32 v174, v174
    v_exp_f32 v142, v142
    v_exp_f32 v175, v175
    v_exp_f32 v143, v143
    v_cvt_pk_bf16_f32 v208, v144, v145
    v_cvt_pk_bf16_f32 v212, v112, v113
    v_cvt_pk_bf16_f32 v209, v146, v147
    v_cvt_pk_bf16_f32 v213, v114, v115
    v_cvt_pk_bf16_f32 v210, v148, v149
    v_cvt_pk_bf16_f32 v214, v116, v117
    v_cvt_pk_bf16_f32 v211, v150, v151
    v_cvt_pk_bf16_f32 v215, v118, v119
    v_cvt_pk_bf16_f32 v216, v152, v153
    v_cvt_pk_bf16_f32 v220, v120, v121
    v_cvt_pk_bf16_f32 v217, v154, v155
    v_cvt_pk_bf16_f32 v221, v122, v123
    v_cvt_pk_bf16_f32 v218, v156, v157
    v_cvt_pk_bf16_f32 v222, v124, v125
    v_cvt_pk_bf16_f32 v219, v158, v159
    v_cvt_pk_bf16_f32 v223, v126, v127
    v_cvt_pk_bf16_f32 v224, v160, v161
    v_cvt_pk_bf16_f32 v228, v128, v129
    v_cvt_pk_bf16_f32 v225, v162, v163
    v_cvt_pk_bf16_f32 v229, v130, v131
    v_cvt_pk_bf16_f32 v226, v164, v165
    v_cvt_pk_bf16_f32 v230, v132, v133
    v_cvt_pk_bf16_f32 v227, v166, v167
    v_cvt_pk_bf16_f32 v231, v134, v135
    v_cvt_pk_bf16_f32 v232, v168, v169
    v_cvt_pk_bf16_f32 v236, v136, v137
    v_cvt_pk_bf16_f32 v233, v170, v171
    v_cvt_pk_bf16_f32 v237, v138, v139
    v_cvt_pk_bf16_f32 v234, v172, v173
    v_cvt_pk_bf16_f32 v238, v140, v141
    v_cvt_pk_bf16_f32 v235, v174, v175
    v_cvt_pk_bf16_f32 v239, v142, v143
    s_branch KA_common
K1_loader:
    s_sub_u32 s23, s16, 4
    v_lshlrev_b32 v2, 4, v1
    s_mul_i32 s24, s23, 2
    s_add_u32 s24, s24, s44
    s_mul_i32 s24, s24, 32768
    v_add_u32 v3, s24, v2
    s_add_u32 s24, s24, 32768
    v_add_u32 v4, s24, v2
    s_mov_b32 s24, 6144
    v_lshrrev_b32 v5, 3, v1
    v_mul_lo_u32 v7, v5, s24
    v_bfe_u32 v5, v1, 4, 2
    v_lshlrev_b32 v5, 1, v5
    v_and_b32 v6, 7, v1
    v_xor_b32 v5, v5, v6
    v_lshl_add_u32 v7, v5, 4, v7
    s_mul_i32 s25, s23, 98304
    s_add_u32 s24, s25, s45
    v_add_u32 v8, s24, v7
    v_add_u32 v9, 48128, v8
    s_add_u32 s24, s25, s46
    v_add_u32 v10, s24, v7
    v_add_u32 v11, 48128, v10
    s_add_u32 s24, s25, s47
    v_add_u32 v12, s24, v7
    v_add_u32 v13, 48128, v12
    s_mul_i32 s27, s23, 4096
    s_lshl_b32 s28, s23, 11
    s_sub_u32 s49, s16, 4
    s_lshr_b32 s38, s49, 1
    s_and_b32 s39, s49, 1
    s_mov_b32 s12, s36
    s_mov_b32 s13, s37
    s_mov_b32 s14, 0x10000
    s_mov_b32 s15, 0x20000
    s_lshl_b32 s48, s18, 1
    s_add_u32 s48, s48, s39
    v_lshlrev_b32 v28, 2, v1
    v_add_u32 v28, 155648, v28
    v_mov_b32 v29, 0
    ds_write_b32 v28, v29
    s_waitcnt lgkmcnt(0)
    s_mov_b32 s20, 0
    s_mov_b32 s21, 0
    s_mov_b32 s22, 0
    s_add_u32 m0, s20, s27
    s_nop 0
    buffer_load_dwordx4 v3, s[4:7], s21 offen offset:0  lds
    buffer_load_dwordx4 v3, s[4:7], s21 offen offset:1024  lds
    s_add_u32 m0, m0, 2048
    s_nop 0
    buffer_load_dwordx4 v4, s[4:7], s21 offen offset:0  lds
    buffer_load_dwordx4 v4, s[4:7], s21 offen offset:1024  lds
    s_add_u32 s24, s20, s28
    s_add_u32 m0, s24, 16384
    s_nop 0
    buffer_load_dwordx4 v8, s[8:11], s22 offen offset:0  lds
    buffer_load_dwordx4 v9, s[8:11], s22 offen offset:1024  lds
    s_add_u32 m0, s24, 24576
    s_nop 0
    buffer_load_dwordx4 v10, s[8:11], s22 offen offset:0  lds
    buffer_load_dwordx4 v11, s[8:11], s22 offen offset:1024  lds
    s_add_u32 m0, s24, 32768
    s_nop 0
    buffer_load_dwordx4 v12, s[8:11], s22 offen offset:0  lds
    buffer_load_dwordx4 v13, s[8:11], s22 offen offset:1024  lds
    s_add_u32 s21, s21, 2048
    s_add_u32 s22, s22, 393216
    s_add_u32 s20, s20, 40960
    s_cmp_eq_u32 s20, 122880
    s_cselect_b32 s20, 0, s20
    s_add_u32 m0, s20, s27
    s_nop 0
    buffer_load_dwordx4 v3, s[4:7], s21 offen offset:0  lds
    buffer_load_dwordx4 v3, s[4:7], s21 offen offset:1024  lds
    s_add_u32 m0, m0, 2048
    s_nop 0
    buffer_load_dwordx4 v4, s[4:7], s21 offen offset:0  lds
    buffer_load_dwordx4 v4, s[4:7], s21 offen offset:1024  lds
    s_add_u32 s24, s20, s28
    s_add_u32 m0, s24, 16384
    s_nop 0
    buffer_load_dwordx4 v8, s[8:11], s22 offen offset:0  lds
    buffer_load_dwordx4 v9, s[8:11], s22 offen offset:1024  lds
    s_add_u32 m0, s24, 24576
    s_nop 0
    buffer_load_dwordx4 v10, s[8:11], s22 offen offset:0  lds
    buffer_load_dwordx4 v11, s[8:11], s22 offen offset:1024  lds
    s_add_u32 m0, s24, 32768
    s_nop 0
    buffer_load_dwordx4 v12, s[8:11], s22 offen offset:0  lds
    buffer_load_dwordx4 v13, s[8:11], s22 offen offset:1024  lds
    s_add_u32 s21, s21, 2048
    s_add_u32 s22, s22, 393216
    s_add_u32 s20, s20, 40960
    s_cmp_eq_u32 s20, 122880
    s_cselect_b32 s20, 0, s20
    s_waitcnt vmcnt(10)
    s_barrier
    s_add_u32 m0, s20, s27
    s_nop 0
    buffer_load_dwordx4 v3, s[4:7], s21 offen offset:0  lds
    buffer_load_dwordx4 v3, s[4:7], s21 offen offset:1024  lds
    s_add_u32 m0, m0, 2048
    s_nop 0
    buffer_load_dwordx4 v4, s[4:7], s21 offen offset:0  lds
    buffer_load_dwordx4 v4, s[4:7], s21 offen offset:1024  lds
    s_add_u32 s24, s20, s28
    s_add_u32 m0, s24, 16384
    s_nop 0
    buffer_load_dwordx4 v8, s[8:11], s22 offen offset:0  lds
    buffer_load_dwordx4 v9, s[8:11], s22 offen offset:1024  lds
    s_add_u32 m0, s24, 24576
    s_nop 0
    buffer_load_dwordx4 v10, s[8:11], s22 offen offset:0  lds
    buffer_load_dwordx4 v11, s[8:11], s22 offen offset:1024  lds
    s_add_u32 m0, s24, 32768
    s_nop 0
    buffer_load_dwordx4 v12, s[8:11], s22 offen offset:0  lds
    buffer_load_dwordx4 v13, s[8:11], s22 offen offset:1024  lds
    s_add_u32 s21, s21, 2048
    s_add_u32 s22, s22, 393216
    s_add_u32 s20, s20, 40960
    s_cmp_eq_u32 s20, 122880
    s_cselect_b32 s20, 0, s20
    s_mov_b32 s19, 13
K1_lloop:
    s_waitcnt vmcnt(10)
    s_barrier
    s_add_u32 m0, s20, s27
    s_nop 0
    buffer_load_dwordx4 v3, s[4:7], s21 offen offset:0  lds
    buffer_load_dwordx4 v3, s[4:7], s21 offen offset:1024  lds
    s_add_u32 m0, m0, 2048
    s_nop 0
    buffer_load_dwordx4 v4, s[4:7], s21 offen offset:0  lds
    buffer_load_dwordx4 v4, s[4:7], s21 offen offset:1024  lds
    s_add_u32 s24, s20, s28
    s_add_u32 m0, s24, 16384
    s_nop 0
    buffer_load_dwordx4 v8, s[8:11], s22 offen offset:0  lds
    buffer_load_dwordx4 v9, s[8:11], s22 offen offset:1024  lds
    s_add_u32 m0, s24, 24576
    s_nop 0
    buffer_load_dwordx4 v10, s[8:11], s22 offen offset:0  lds
    buffer_load_dwordx4 v11, s[8:11], s22 offen offset:1024  lds
    s_add_u32 m0, s24, 32768
    s_nop 0
    buffer_load_dwordx4 v12, s[8:11], s22 offen offset:0  lds
    buffer_load_dwordx4 v13, s[8:11], s22 offen offset:1024  lds
    s_add_u32 s21, s21, 2048
    s_add_u32 s22, s22, 393216
    s_add_u32 s20, s20, 40960
    s_cmp_eq_u32 s20, 122880
    s_cselect_b32 s20, 0, s20
K1_hookret:
    s_sub_u32 s19, s19, 1
    s_cmp_lg_u32 s19, 0
    s_cbranch_scc1 K1_lloop
    s_lshl_b32 s41, s48, 11
    v_lshrrev_b32 v30, 4, v1
    v_lshlrev_b32 v30, 8, v30
    v_and_b32 v31, 15, v1
    v_lshl_add_u32 v30, v31, 1, v30
    v_add_u32 v30, s41, v30
    buffer_load_ushort v96, v30, s[12:15], 0 offen offset:0
    buffer_load_ushort v97, v30, s[12:15], 0 offen offset:64
    buffer_load_ushort v98, v30, s[12:15], 0 offen offset:128
    buffer_load_ushort v99, v30, s[12:15], 0 offen offset:192
    buffer_load_ushort v100, v30, s[12:15], 0 offen offset:1024
    buffer_load_ushort v101, v30, s[12:15], 0 offen offset:1088
    buffer_load_ushort v102, v30, s[12:15], 0 offen offset:1152
    buffer_load_ushort v103, v30, s[12:15], 0 offen offset:1216
    buffer_load_ushort v104, v30, s[12:15], 0 offen offset:32
    buffer_load_ushort v105, v30, s[12:15], 0 offen offset:96
    buffer_load_ushort v106, v30, s[12:15], 0 offen offset:160
    buffer_load_ushort v107, v30, s[12:15], 0 offen offset:224
    buffer_load_ushort v108, v30, s[12:15], 0 offen offset:1056
    buffer_load_ushort v109, v30, s[12:15], 0 offen offset:1120
    buffer_load_ushort v110, v30, s[12:15], 0 offen offset:1184
    buffer_load_ushort v111, v30, s[12:15], 0 offen offset:1248
    s_waitcnt vmcnt(26)
    s_barrier
    s_waitcnt vmcnt(16)
    s_barrier
    s_mov_b32 s46, 0x3fb8aa3b
    s_mov_b32 s47, 0x3fb8aa3b
    s_add_u32 s52, s34, 0xc00000
    s_addc_u32 s53, s35, 0
    s_mov_b32 s54, 0x800000
    s_mov_b32 s55, 0x20000
    s_waitcnt vmcnt(0)
    v_lshl_or_b32 v96, v97, 16, v96
    v_lshl_or_b32 v97, v99, 16, v98
    v_lshl_or_b32 v98, v101, 16, v100
    v_lshl_or_b32 v99, v103, 16, v102
    v_lshl_or_b32 v100, v105, 16, v104
    v_lshl_or_b32 v101, v107, 16, v106
    v_lshl_or_b32 v102, v109, 16, v108
    v_lshl_or_b32 v103, v111, 16, v110
    s_barrier
    s_setprio 3
    v_lshlrev_b32 v9, 4, v1
    s_lshl_b32 s41, s49, 13
    s_add_u32 s41, s41, 122880
    v_add_u32 v9, s41, v9
    ds_read_b128 v[16:19], v9 offset:0
    ds_read_b128 v[20:23], v9 offset:1024
    ds_read_b128 v[24:27], v9 offset:2048
    ds_read_b128 v[28:31], v9 offset:3072
    s_waitcnt lgkmcnt(0)
    v_mfma_f32_16x16x32_bf16 v[112:115], v[96:99], v[16:19], 0
    v_mfma_f32_16x16x32_bf16 v[116:119], v[100:103], v[16:19], 0
    v_mfma_f32_16x16x32_bf16 v[120:123], v[96:99], v[20:23], 0
    v_mfma_f32_16x16x32_bf16 v[124:127], v[100:103], v[20:23], 0
    v_mfma_f32_16x16x32_bf16 v[128:131], v[96:99], v[24:27], 0
    v_mfma_f32_16x16x32_bf16 v[132:135], v[100:103], v[24:27], 0
    v_mfma_f32_16x16x32_bf16 v[136:139], v[96:99], v[28:31], 0
    v_mfma_f32_16x16x32_bf16 v[140:143], v[100:103], v[28:31], 0
    v_and_b32 v9, 15, v1
    v_lshlrev_b32 v10, 7, v9
    v_bfe_u32 v11, v1, 1, 2
    v_lshlrev_b32 v11, 1, v11
    v_lshrrev_b32 v12, 5, v1
    v_xor_b32 v11, v11, v12
    v_lshl_add_u32 v10, v11, 4, v10
    v_bfe_u32 v11, v1, 4, 1
    v_lshl_add_u32 v10, v11, 3, v10
    s_lshl_b32 s41, s39, 14
    s_lshl_b32 s42, s38, 13
    s_add_u32 s41, s41, s42
    v_add_u32 v10, s41, v10
    v_xor_b32 v11, 32, v10
    v_xor_b32 v12, 64, v10
    v_xor_b32 v13, 96, v10
    v_max3_f32 v176, v112, v113, v114
    v_min3_f32 v184, v112, v113, v114
    v_max3_f32 v178, v120, v121, v122
    v_min3_f32 v186, v120, v121, v122
    v_max3_f32 v180, v128, v129, v130
    v_min3_f32 v188, v128, v129, v130
    v_max3_f32 v182, v136, v137, v138
    v_min3_f32 v190, v136, v137, v138
    v_max3_f32 v176, v176, v115, v116
    v_min3_f32 v184, v184, v115, v116
    v_max3_f32 v178, v178, v123, v124
    v_min3_f32 v186, v186, v123, v124
    v_max3_f32 v180, v180, v131, v132
    v_min3_f32 v188, v188, v131, v132
    v_max3_f32 v182, v182, v139, v140
    v_min3_f32 v190, v190, v139, v140
    v_max3_f32 v176, v176, v117, v118
    v_min3_f32 v184, v184, v117, v118
    v_max3_f32 v178, v178, v125, v126
    v_min3_f32 v186, v186, v125, v126
    v_max3_f32 v180, v180, v133, v134
    v_min3_f32 v188, v188, v133, v134
    v_max3_f32 v182, v182, v141, v142
    v_min3_f32 v190, v190, v141, v142
    v_max_f32 v176, v176, v119
    v_min_f32 v184, v184, v119
    v_max_f32 v178, v178, v127
    v_min_f32 v186, v186, v127
    v_max_f32 v180, v180, v135
    v_min_f32 v188, v188, v135
    v_max_f32 v182, v182, v143
    v_min_f32 v190, v190, v143
    v_permlane32_swap_b32 v176, v178
    v_permlane32_swap_b32 v184, v186
    v_permlane32_swap_b32 v180, v182
    v_permlane32_swap_b32 v188, v190
    v_max_f32 v176, v176, v178
    v_min_f32 v184, v184, v186
    v_max_f32 v180, v180, v182
    v_min_f32 v188, v188, v190
    s_nop 0
    v_permlane16_swap_b32 v176, v180
    v_permlane16_swap_b32 v184, v188
    v_max_f32 v176, v176, v180
    v_min_f32 v184, v184, v188
    v_mov_b32 v180, v176
    v_mov_b32 v188, v184
    s_nop 0
    v_permlane16_swap_b32 v176, v180
    v_permlane16_swap_b32 v184, v188
    v_mov_b32 v178, v176
    v_mov_b32 v186, v184
    v_mov_b32 v182, v180
    v_mov_b32 v190, v188
    v_permlane32_swap_b32 v176, v178
    v_permlane32_swap_b32 v184, v186
    v_permlane32_swap_b32 v180, v182
    v_permlane32_swap_b32 v188, v190
    v_mul_f32 v176, s46, v176
    v_mul_f32 v184, s46, v184
    v_mul_f32 v178, s46, v178
    v_mul_f32 v186, s46, v186
    v_mul_f32 v180, s46, v180
    v_mul_f32 v188, s46, v188
    v_mul_f32 v182, s46, v182
    v_mul_f32 v190, s46, v190
    v_pk_fma_f32 v[144:145], v[112:113], s[46:47], v[176:177] op_sel_hi:[1,1,0] neg_lo:[0,0,1] neg_hi:[0,0,1]
    v_pk_fma_f32 v[112:113], v[112:113], s[46:47], v[184:185] op_sel_hi:[1,1,0] neg_lo:[1,0,0] neg_hi:[1,0,0]
    v_pk_fma_f32 v[146:147], v[114:115], s[46:47], v[176:177] op_sel_hi:[1,1,0] neg_lo:[0,0,1] neg_hi:[0,0,1]
    v_pk_fma_f32 v[114:115], v[114:115], s[46:47], v[184:185] op_sel_hi:[1,1,0] neg_lo:[1,0,0] neg_hi:[1,0,0]
    v_pk_fma_f32 v[148:149], v[116:117], s[46:47], v[176:177] op_sel_hi:[1,1,0] neg_lo:[0,0,1] neg_hi:[0,0,1]
    v_pk_fma_f32 v[116:117], v[116:117], s[46:47], v[184:185] op_sel_hi:[1,1,0] neg_lo:[1,0,0] neg_hi:[1,0,0]
    v_pk_fma_f32 v[150:151], v[118:119], s[46:47], v[176:177] op_sel_hi:[1,1,0] neg_lo:[0,0,1] neg_hi:[0,0,1]
    v_pk_fma_f32 v[118:119], v[118:119], s[46:47], v[184:185] op_sel_hi:[1,1,0] neg_lo:[1,0,0] neg_hi:[1,0,0]
    v_pk_fma_f32 v[152:153], v[120:121], s[46:47], v[178:179] op_sel_hi:[1,1,0] neg_lo:[0,0,1] neg_hi:[0,0,1]
    v_pk_fma_f32 v[120:121], v[120:121], s[46:47], v[186:187] op_sel_hi:[1,1,0] neg_lo:[1,0,0] neg_hi:[1,0,0]
    v_pk_fma_f32 v[154:155], v[122:123], s[46:47], v[178:179] op_sel_hi:[1,1,0] neg_lo:[0,0,1] neg_hi:[0,0,1]
    v_pk_fma_f32 v[122:123], v[122:123], s[46:47], v[186:187] op_sel_hi:[1,1,0] neg_lo:[1,0,0] neg_hi:[1,0,0]
    v_pk_fma_f32 v[156:157], v[124:125], s[46:47], v[178:179] op_sel_hi:[1,1,0] neg_lo:[0,0,1] neg_hi:[0,0,1]
    v_pk_fma_f32 v[124:125], v[124:125], s[46:47], v[186:187] op_sel_hi:[1,1,0] neg_lo:[1,0,0] neg_hi:[1,0,0]
    v_pk_fma_f32 v[158:159], v[126:127], s[46:47], v[178:179] op_sel_hi:[1,1,0] neg_lo:[0,0,1] neg_hi:[0,0,1]
    v_pk_fma_f32 v[126:127], v[126:127], s[46:47], v[186:187] op_sel_hi:[1,1,0] neg_lo:[1,0,0] neg_hi:[1,0,0]
    v_pk_fma_f32 v[160:161], v[128:129], s[46:47], v[180:181] op_sel_hi:[1,1,0] neg_lo:[0,0,1] neg_hi:[0,0,1]
    v_pk_fma_f32 v[128:129], v[128:129], s[46:47], v[188:189] op_sel_hi:[1,1,0] neg_lo:[1,0,0] neg_hi:[1,0,0]
    v_pk_fma_f32 v[162:163], v[130:131], s[46:47], v[180:181] op_sel_hi:[1,1,0] neg_lo:[0,0,1] neg_hi:[0,0,1]
    v_pk_fma_f32 v[130:131], v[130:131], s[46:47], v[188:189] op_sel_hi:[1,1,0] neg_lo:[1,0,0] neg_hi:[1,0,0]
    v_pk_fma_f32 v[164:165], v[132:133], s[46:47], v[180:181] op_sel_hi:[1,1,0] neg_lo:[0,0,1] neg_hi:[0,0,1]
    v_pk_fma_f32 v[132:133], v[132:133], s[46:47], v[188:189] op_sel_hi:[1,1,0] neg_lo:[1,0,0] neg_hi:[1,0,0]
    v_pk_fma_f32 v[166:167], v[134:135], s[46:47], v[180:181] op_sel_hi:[1,1,0] neg_lo:[0,0,1] neg_hi:[0,0,1]
    v_pk_fma_f32 v[134:135], v[134:135], s[46:47], v[188:189] op_sel_hi:[1,1,0] neg_lo:[1,0,0] neg_hi:[1,0,0]
    v_pk_fma_f32 v[168:169], v[136:137], s[46:47], v[182:183] op_sel_hi:[1,1,0] neg_lo:[0,0,1] neg_hi:[0,0,1]
    v_pk_fma_f32 v[136:137], v[136:137], s[46:47], v[190:191] op_sel_hi:[1,1,0] neg_lo:[1,0,0] neg_hi:[1,0,0]
    v_pk_fma_f32 v[170:171], v[138:139], s[46:47], v[182:183] op_sel_hi:[1,1,0] neg_lo:[0,0,1] neg_hi:[0,0,1]
    v_pk_fma_f32 v[138:139], v[138:139], s[46:47], v[190:191] op_sel_hi:[1,1,0] neg_lo:[1,0,0] neg_hi:[1,0,0]
    v_pk_fma_f32 v[172:173], v[140:141], s[46:47], v[182:183] op_sel_hi:[1,1,0] neg_lo:[0,0,1] neg_hi:[0,0,1]
    v_pk_fma_f32 v[140:141], v[140:141], s[46:47], v[190:191] op_sel_hi:[1,1,0] neg_lo:[1,0,0] neg_hi:[1,0,0]
    v_pk_fma_f32 v[174:175], v[142:143], s[46:47], v[182:183] op_sel_hi:[1,1,0] neg_lo:[0,0,1] neg_hi:[0,0,1]
    v_pk_fma_f32 v[142:143], v[142:143], s[46:47], v[190:191] op_sel_hi:[1,1,0] neg_lo:[1,0,0] neg_hi:[1,0,0]
    v_exp_f32 v144, v144
    v_exp_f32 v112, v112
    v_exp_f32 v145, v145
    v_exp_f32 v113, v113
    v_exp_f32 v146, v146
    v_exp_f32 v114, v114
    v_exp_f32 v147, v147
    v_exp_f32 v115, v115
    v_exp_f32 v148, v148
    v_exp_f32 v116, v116
    v_exp_f32 v149, v149
    v_exp_f32 v117, v117
    v_exp_f32 v150, v150
    v_exp_f32 v118, v118
    v_exp_f32 v151, v151
    v_exp_f32 v119, v119
    v_exp_f32 v152, v152
    v_exp_f32 v120, v120
    v_exp_f32 v153, v153
    v_exp_f32 v121, v121
    v_exp_f32 v154, v154
    v_exp_f32 v122, v122
    v_exp_f32 v155, v155
    v_exp_f32 v123, v123
    v_exp_f32 v156, v156
    v_exp_f32 v124, v124
    v_exp_f32 v157, v157
    v_exp_f32 v125, v125
    v_exp_f32 v158, v158
    v_exp_f32 v126, v126
    v_exp_f32 v159, v159
    v_exp_f32 v127, v127
    v_exp_f32 v160, v160
    v_exp_f32 v128, v128
    v_exp_f32 v161, v161
    v_exp_f32 v129, v129
    v_exp_f32 v162, v162
    v_exp_f32 v130, v130
    v_exp_f32 v163, v163
    v_exp_f32 v131, v131
    v_exp_f32 v164, v164
    v_exp_f32 v132, v132
    v_exp_f32 v165, v165
    v_exp_f32 v133, v133
    v_exp_f32 v166, v166
    v_exp_f32 v134, v134
    v_exp_f32 v167, v167
    v_exp_f32 v135, v135
    v_exp_f32 v168, v168
    v_exp_f32 v136, v136
    v_exp_f32 v169, v169
    v_exp_f32 v137, v137
    v_exp_f32 v170, v170
    v_exp_f32 v138, v138
    v_exp_f32 v171, v171
    v_exp_f32 v139, v139
    v_exp_f32 v172, v172
    v_exp_f32 v140, v140
    v_exp_f32 v173, v173
    v_exp_f32 v141, v141
    v_exp_f32 v174, v174
    v_exp_f32 v142, v142
    v_exp_f32 v175, v175
    v_exp_f32 v143, v143
    v_pk_add_f32 v[176:177], v[144:145], v[146:147]
    v_pk_add_f32 v[184:185], v[112:113], v[114:115]
    v_pk_add_f32 v[178:179], v[152:153], v[154:155]
    v_pk_add_f32 v[186:187], v[120:121], v[122:123]
    v_pk_add_f32 v[180:181], v[160:161], v[162:163]
    v_pk_add_f32 v[188:189], v[128:129], v[130:131]
    v_pk_add_f32 v[182:183], v[168:169], v[170:171]
    v_pk_add_f32 v[190:191], v[136:137], v[138:139]
    v_pk_add_f32 v[176:177], v[176:177], v[148:149]
    v_pk_add_f32 v[184:185], v[184:185], v[116:117]
    v_pk_add_f32 v[178:179], v[178:179], v[156:157]
    v_pk_add_f32 v[186:187], v[186:187], v[124:125]
    v_pk_add_f32 v[180:181], v[180:181], v[164:165]
    v_pk_add_f32 v[188:189], v[188:189], v[132:133]
    v_pk_add_f32 v[182:183], v[182:183], v[172:173]
    v_pk_add_f32 v[190:191], v[190:191], v[140:141]
    v_pk_add_f32 v[176:177], v[176:177], v[150:151]
    v_pk_add_f32 v[184:185], v[184:185], v[118:119]
    v_pk_add_f32 v[178:179], v[178:179], v[158:159]
    v_pk_add_f32 v[186:187], v[186:187], v[126:127]
    v_pk_add_f32 v[180:181], v[180:181], v[166:167]
    v_pk_add_f32 v[188:189], v[188:189], v[134:135]
    v_pk_add_f32 v[182:183], v[182:183], v[174:175]
    v_pk_add_f32 v[190:191], v[190:191], v[142:143]
    v_add_f32 v176, v176, v177
    v_add_f32 v184, v184, v185
    v_add_f32 v178, v178, v179
    v_add_f32 v186, v186, v187
    v_add_f32 v180, v180, v181
    v_add_f32 v188, v188, v189
    v_add_f32 v182, v182, v183
    v_add_f32 v190, v190, v191
    v_permlane32_swap_b32 v176, v178
    v_permlane32_swap_b32 v184, v186
    v_permlane32_swap_b32 v180, v182
    v_permlane32_swap_b32 v188, v190
    v_add_f32 v176, v176, v178
    v_add_f32 v184, v184, v186
    v_add_f32 v180, v180, v182
    v_add_f32 v188, v188, v190
    s_nop 0
    v_permlane16_swap_b32 v176, v180
    v_permlane16_swap_b32 v184, v188
    v_add_f32 v176, v176, v180
    v_add_f32 v184, v184, v188
    v_mov_b32 v180, v176
    v_mov_b32 v188, v184
    s_nop 0
    v_permlane16_swap_b32 v176, v180
    v_permlane16_swap_b32 v184, v188
    v_mov_b32 v178, v176
    v_mov_b32 v186, v184
    v_mov_b32 v182, v180
    v_mov_b32 v190, v188
    v_permlane32_swap_b32 v176, v178
    v_permlane32_swap_b32 v184, v186
    v_permlane32_swap_b32 v180, v182
    v_permlane32_swap_b32 v188, v190
    v_rcp_f32 v176, v176
    v_rcp_f32 v184, v184
    v_rcp_f32 v178, v178
    v_rcp_f32 v186, v186
    v_rcp_f32 v180, v180
    v_rcp_f32 v188, v188
    v_rcp_f32 v182, v182
    v_rcp_f32 v190, v190
    v_pk_mul_f32 v[144:145], v[144:145], v[176:177] op_sel_hi:[1,0]
    v_pk_mul_f32 v[112:113], v[112:113], v[184:185] op_sel_hi:[1,0]
    v_pk_mul_f32 v[146:147], v[146:147], v[176:177] op_sel_hi:[1,0]
    v_pk_mul_f32 v[114:115], v[114:115], v[184:185] op_sel_hi:[1,0]
    v_pk_mul_f32 v[148:149], v[148:149], v[176:177] op_sel_hi:[1,0]
    v_pk_mul_f32 v[116:117], v[116:117], v[184:185] op_sel_hi:[1,0]
    v_pk_mul_f32 v[150:151], v[150:151], v[176:177] op_sel_hi:[1,0]
    v_pk_mul_f32 v[118:119], v[118:119], v[184:185] op_sel_hi:[1,0]
    v_pk_mul_f32 v[152:153], v[152:153], v[178:179] op_sel_hi:[1,0]
    v_pk_mul_f32 v[120:121], v[120:121], v[186:187] op_sel_hi:[1,0]
    v_pk_mul_f32 v[154:155], v[154:155], v[178:179] op_sel_hi:[1,0]
    v_pk_mul_f32 v[122:123], v[122:123], v[186:187] op_sel_hi:[1,0]
    v_pk_mul_f32 v[156:157], v[156:157], v[178:179] op_sel_hi:[1,0]
    v_pk_mul_f32 v[124:125], v[124:125], v[186:187] op_sel_hi:[1,0]
    v_pk_mul_f32 v[158:159], v[158:159], v[178:179] op_sel_hi:[1,0]
    v_pk_mul_f32 v[126:127], v[126:127], v[186:187] op_sel_hi:[1,0]
    v_pk_mul_f32 v[160:161], v[160:161], v[180:181] op_sel_hi:[1,0]
    v_pk_mul_f32 v[128:129], v[128:129], v[188:189] op_sel_hi:[1,0]
    v_pk_mul_f32 v[162:163], v[162:163], v[180:181] op_sel_hi:[1,0]
    v_pk_mul_f32 v[130:131], v[130:131], v[188:189] op_sel_hi:[1,0]
    v_pk_mul_f32 v[164:165], v[164:165], v[180:181] op_sel_hi:[1,0]
    v_pk_mul_f32 v[132:133], v[132:133], v[188:189] op_sel_hi:[1,0]
    v_pk_mul_f32 v[166:167], v[166:167], v[180:181] op_sel_hi:[1,0]
    v_pk_mul_f32 v[134:135], v[134:135], v[188:189] op_sel_hi:[1,0]
    v_pk_mul_f32 v[168:169], v[168:169], v[182:183] op_sel_hi:[1,0]
    v_pk_mul_f32 v[136:137], v[136:137], v[190:191] op_sel_hi:[1,0]
    v_pk_mul_f32 v[170:171], v[170:171], v[182:183] op_sel_hi:[1,0]
    v_pk_mul_f32 v[138:139], v[138:139], v[190:191] op_sel_hi:[1,0]
    v_pk_mul_f32 v[172:173], v[172:173], v[182:183] op_sel_hi:[1,0]
    v_pk_mul_f32 v[140:141], v[140:141], v[190:191] op_sel_hi:[1,0]
    v_pk_mul_f32 v[174:175], v[174:175], v[182:183] op_sel_hi:[1,0]
    v_pk_mul_f32 v[142:143], v[142:143], v[190:191] op_sel_hi:[1,0]
    v_cvt_pk_bf16_f32 v16, v144, v145
    v_cvt_pk_bf16_f32 v20, v112, v113
    v_cvt_pk_bf16_f32 v17, v146, v147
    v_cvt_pk_bf16_f32 v21, v114, v115
    v_cvt_pk_bf16_f32 v18, v148, v149
    v_cvt_pk_bf16_f32 v22, v116, v117
    v_cvt_pk_bf16_f32 v19, v150, v151
    v_cvt_pk_bf16_f32 v23, v118, v119
    ds_write_b64 v10, v[16:17] offset:0
    ds_write_b64 v11, v[18:19] offset:0
    ds_write_b64 v12, v[20:21] offset:0
    ds_write_b64 v13, v[22:23] offset:0
    v_cvt_pk_bf16_f32 v24, v152, v153
    v_cvt_pk_bf16_f32 v28, v120, v121
    v_cvt_pk_bf16_f32 v25, v154, v155
    v_cvt_pk_bf16_f32 v29, v122, v123
    v_cvt_pk_bf16_f32 v26, v156, v157
    v_cvt_pk_bf16_f32 v30, v124, v125
    v_cvt_pk_bf16_f32 v27, v158, v159
    v_cvt_pk_bf16_f32 v31, v126, v127
    ds_write_b64 v10, v[24:25] offset:2048
    ds_write_b64 v11, v[26:27] offset:2048
    ds_write_b64 v12, v[28:29] offset:2048
    ds_write_b64 v13, v[30:31] offset:2048
    v_cvt_pk_bf16_f32 v32, v160, v161
    v_cvt_pk_bf16_f32 v36, v128, v129
    v_cvt_pk_bf16_f32 v33, v162, v163
    v_cvt_pk_bf16_f32 v37, v130, v131
    v_cvt_pk_bf16_f32 v34, v164, v165
    v_cvt_pk_bf16_f32 v38, v132, v133
    v_cvt_pk_bf16_f32 v35, v166, v167
    v_cvt_pk_bf16_f32 v39, v134, v135
    ds_write_b64 v10, v[32:33] offset:4096
    ds_write_b64 v11, v[34:35] offset:4096
    ds_write_b64 v12, v[36:37] offset:4096
    ds_write_b64 v13, v[38:39] offset:4096
    v_cvt_pk_bf16_f32 v40, v168, v169
    v_cvt_pk_bf16_f32 v44, v136, v137
    v_cvt_pk_bf16_f32 v41, v170, v171
    v_cvt_pk_bf16_f32 v45, v138, v139
    v_cvt_pk_bf16_f32 v42, v172, v173
    v_cvt_pk_bf16_f32 v46, v140, v141
    v_cvt_pk_bf16_f32 v43, v174, v175
    v_cvt_pk_bf16_f32 v47, v142, v143
    ds_write_b64 v10, v[40:41] offset:6144
    ds_write_b64 v11, v[42:43] offset:6144
    ds_write_b64 v12, v[44:45] offset:6144
    ds_write_b64 v13, v[46:47] offset:6144
    v_bfe_u32 v14, v1, 1, 1
    v_bfe_u32 v15, v1, 3, 2
    v_lshlrev_b32 v15, 1, v15
    v_xor_b32 v14, v14, v15
    v_lshrrev_b32 v15, 2, v1
    v_lshlrev_b32 v3, 7, v15
    v_lshl_add_u32 v3, v14, 4, v3
    v_and_b32 v15, 1, v1
    v_lshl_add_u32 v3, v15, 3, v3
    s_lshl_b32 s41, s39, 14
    v_add_u32 v3, s41, v3
    s_lshl_b32 s41, s38, 6
    v_xor_b32 v3, s41, v3
    v_xor_b32 v4, 32, v3
    v_lshlrev_b32 v9, 4, v1
    s_lshl_b32 s41, s39, 13
    s_add_u32 s41, s41, 126976
    v_add_u32 v9, s41, v9
    ds_read_b128 v[48:51], v9 offset:0
    ds_read_b128 v[52:55], v9 offset:1024
    ds_read_b128 v[56:59], v9 offset:2048
    ds_read_b128 v[60:63], v9 offset:3072
    ds_read_b128 v[64:67], v9 offset:16384
    ds_read_b128 v[68:71], v9 offset:17408
    ds_read_b128 v[72:75], v9 offset:18432
    ds_read_b128 v[76:79], v9 offset:19456
    v_mov_b32 v88, 0x3f803f80
    v_mov_b32 v89, 0x3f803f80
    v_mov_b32 v90, 0x3f803f80
    v_mov_b32 v91, 0x3f803f80
    s_waitcnt lgkmcnt(0)
    s_lshl_b32 s41, s49, 2
    s_add_u32 s41, s41, 155648
    v_mov_b32 v14, s41
    v_mov_b32 v15, 1
    ds_write_b32 v14, v15
    v_xor_b32 v14, 8, v14
    s_mov_b32 s77, 0x100000
KA_pair:
    ds_read_b32 v15, v14
    s_waitcnt lgkmcnt(0)
    v_readfirstlane_b32 s78, v15
    s_nop 3
    s_cmp_eq_u32 s78, 1
    s_cbranch_scc1 KA_pair_done
    s_sub_u32 s77, s77, 1
    s_cmp_lg_u32 s77, 0
    s_cbranch_scc1 KA_pair
KA_pair_done:
    ds_read_b64_tr_b16 v[16:17], v3 offset:0
    ds_read_b64_tr_b16 v[18:19], v3 offset:2048
    ds_read_b64_tr_b16 v[20:21], v4 offset:0
    ds_read_b64_tr_b16 v[22:23], v4 offset:2048
    ds_read_b64_tr_b16 v[24:25], v3 offset:4096
    ds_read_b64_tr_b16 v[26:27], v3 offset:6144
    ds_read_b64_tr_b16 v[28:29], v4 offset:4096
    ds_read_b64_tr_b16 v[30:31], v4 offset:6144
    ds_read_b64_tr_b16 v[32:33], v3 offset:8192
    ds_read_b64_tr_b16 v[34:35], v3 offset:10240
    ds_read_b64_tr_b16 v[36:37], v4 offset:8192
    ds_read_b64_tr_b16 v[38:39], v4 offset:10240
    ds_read_b64_tr_b16 v[40:41], v3 offset:12288
    ds_read_b64_tr_b16 v[42:43], v3 offset:14336
    ds_read_b64_tr_b16 v[44:45], v4 offset:12288
    ds_read_b64_tr_b16 v[46:47], v4 offset:14336
    s_waitcnt lgkmcnt(12)
    v_mfma_f32_16x16x32_bf16 v[112:115], v[16:19], v[48:51], 0
    v_mfma_f32_16x16x32_bf16 v[116:119], v[16:19], v[52:55], 0
    v_mfma_f32_16x16x32_bf16 v[120:123], v[16:19], v[88:91], 0
    v_mfma_f32_16x16x32_bf16 v[124:127], v[20:23], v[48:51], 0
    v_mfma_f32_16x16x32_bf16 v[128:131], v[20:23], v[52:55], 0
    v_mfma_f32_16x16x32_bf16 v[132:135], v[20:23], v[88:91], 0
    s_waitcnt lgkmcnt(8)
    v_mfma_f32_16x16x32_bf16 v[112:115], v[24:27], v[56:59], v[112:115]
    v_mfma_f32_16x16x32_bf16 v[116:119], v[24:27], v[60:63], v[116:119]
    v_mfma_f32_16x16x32_bf16 v[120:123], v[24:27], v[88:91], v[120:123]
    v_mfma_f32_16x16x32_bf16 v[124:127], v[28:31], v[56:59], v[124:127]
    v_mfma_f32_16x16x32_bf16 v[128:131], v[28:31], v[60:63], v[128:131]
    v_mfma_f32_16x16x32_bf16 v[132:135], v[28:31], v[88:91], v[132:135]
    s_waitcnt lgkmcnt(4)
    v_mfma_f32_16x16x32_bf16 v[112:115], v[32:35], v[64:67], v[112:115]
    v_mfma_f32_16x16x32_bf16 v[116:119], v[32:35], v[68:71], v[116:119]
    v_mfma_f32_16x16x32_bf16 v[120:123], v[32:35], v[88:91], v[120:123]
    v_mfma_f32_16x16x32_bf16 v[124:127], v[36:39], v[64:67], v[124:127]
    v_mfma_f32_16x16x32_bf16 v[128:131], v[36:39], v[68:71], v[128:131]
    v_mfma_f32_16x16x32_bf16 v[132:135], v[36:39], v[88:91], v[132:135]
    s_waitcnt lgkmcnt(0)
    v_mfma_f32_16x16x32_bf16 v[112:115], v[40:43], v[72:75], v[112:115]
    v_mfma_f32_16x16x32_bf16 v[116:119], v[40:43], v[76:79], v[116:119]
    v_mfma_f32_16x16x32_bf16 v[120:123], v[40:43], v[88:91], v[120:123]
    v_mfma_f32_16x16x32_bf16 v[124:127], v[44:47], v[72:75], v[124:127]
    v_mfma_f32_16x16x32_bf16 v[128:131], v[44:47], v[76:79], v[128:131]
    v_mfma_f32_16x16x32_bf16 v[132:135], v[44:47], v[88:91], v[132:135]
    s_lshl_b32 s41, s48, 4
    s_add_u32 s41, s41, s17
    s_mul_i32 s41, s41, 4352
    s_lshl_b32 s42, s38, 11
    s_add_u32 s42, s42, s41
    v_lshlrev_b32 v9, 4, v1
    v_add_u32 v9, s42, v9
    v_cvt_pk_bf16_f32 v16, v112, v113
    v_cvt_pk_bf16_f32 v17, v114, v115
    v_cvt_pk_bf16_f32 v18, v116, v117
    v_cvt_pk_bf16_f32 v19, v118, v119
    v_cvt_pk_bf16_f32 v20, v120, v121
    v_cvt_pk_bf16_f32 v21, v122, v123
    buffer_store_dwordx4 v[16:19], v9, s[52:55], 0 offen offset:0 sc1
    v_cvt_pk_bf16_f32 v24, v124, v125
    v_cvt_pk_bf16_f32 v25, v126, v127
    v_cvt_pk_bf16_f32 v26, v128, v129
    v_cvt_pk_bf16_f32 v27, v130, v131
    v_cvt_pk_bf16_f32 v28, v132, v133
    v_cvt_pk_bf16_f32 v29, v134, v135
    buffer_store_dwordx4 v[24:27], v9, s[52:55], 0 offen offset:1024 sc1
    v_lshrrev_b32 v9, 4, v1
    v_lshlrev_b32 v9, 3, v9
    s_lshl_b32 s42, s38, 6
    s_add_u32 s41, s41, s42
    s_add_u32 s41, s41, 4096
    v_add_u32 v9, s41, v9
    v_and_b32 v10, 15, v1
    v_cmp_eq_u32 vcc, 0, v10
    s_nop 3
    s_and_saveexec_b64 s[40:41], vcc
    buffer_store_dwordx2 v[20:21], v9, s[52:55], 0 offen offset:0 sc1
    buffer_store_dwordx2 v[28:29], v9, s[52:55], 0 offen offset:32 sc1
    s_mov_b64 exec, s[40:41]
    s_waitcnt vmcnt(0)
    v_mov_b32 v14, 155664
    v_mov_b32 v15, 1
    s_mov_b64 s[78:79], exec
    s_mov_b64 exec, 1
    ds_add_u32 v14, v15
    s_mov_b64 exec, s[78:79]
    s_waitcnt lgkmcnt(0)
    s_setprio 0
KA_common:
    s_and_b32 s30, s2, 7
    s_lshl_b32 s30, s30, 1
    s_bfe_u32 s31, s2, 0x10003
    s_add_u32 s30, s30, s31
    s_lshr_b32 s31, s2, 4
    s_add_u32 s52, s34, 0xc00000
    s_addc_u32 s53, s35, 0
    s_mov_b32 s54, 0x800000
    s_mov_b32 s55, 0x20000
    s_add_u32 s56, s34, 0x1e00000
    s_addc_u32 s57, s35, 0
    s_mov_b32 s58, 0x10000
    s_mov_b32 s59, 0x20000
    s_lshl_b32 s50, s18, 8
    s_lshl_b32 s51, s17, 8
    s_add_u32 s51, s51, 4096
    s_lshl_b32 s29, s30, 8
    s_add_u32 s29, s29, 4096
    v_lshlrev_b32 v2, 4, v1
    s_cmp_lt_u32 s16, 4
    s_cbranch_scc1 KA_redc
    s_cmp_lg_u32 s16, 4
    s_cbranch_scc1 KA_nopoll1
    v_mov_b32 v14, 155664
    s_mov_b32 s77, 0x100000
KA_dr:
    ds_read_b32 v15, v14
    s_waitcnt lgkmcnt(0)
    v_readfirstlane_b32 s78, v15
    s_nop 3
    s_cmp_eq_u32 s78, 4
    s_cbranch_scc1 KA_dr_done
    s_sub_u32 s77, s77, 1
    s_cmp_lg_u32 s77, 0
    s_cbranch_scc1 KA_dr
KA_dr_done:
    v_mov_b32 v40, 1
    v_mov_b32 v41, 0
    s_mov_b64 s[78:79], exec
    s_mov_b64 exec, 1
    buffer_atomic_add v40, v41, s[56:59], s50 offen
    s_mov_b64 exec, s[78:79]
    s_mov_b32 s77, 0x40000
    v_mov_b32 v41, 0
KA_p1:
    buffer_load_dword v40, v41, s[56:59], s50 offen sc1
    s_waitcnt vmcnt(0)
    v_readfirstlane_b32 s78, v40
    s_nop 3
    s_cmp_ge_u32 s78, 16
    s_cbranch_scc1 KA_p1_done
    s_sleep 1
    s_sub_u32 s77, s77, 1
    s_cmp_lg_u32 s77, 0
    s_cbranch_scc1 KA_p1
KA_p1_done:
    v_mov_b32 v14, 155668
    v_mov_b32 v15, 1
    ds_write_b32 v14, v15
    s_waitcnt lgkmcnt(0)
    s_branch KA_kvready
KA_nopoll1:
    v_mov_b32 v14, 155668
    s_mov_b32 s77, 0x400000
KA_kw:
    ds_read_b32 v15, v14
    s_waitcnt lgkmcnt(0)
    v_readfirstlane_b32 s78, v15
    s_nop 3
    s_cmp_eq_u32 s78, 1
    s_cbranch_scc1 KA_kvready
    s_sleep 1
    s_sub_u32 s77, s77, 1
    s_cmp_lg_u32 s77, 0
    s_cbranch_scc1 KA_kw
KA_kvready:
    s_and_b32 s40, s49, 1
    s_lshr_b32 s41, s49, 1
    s_lshl_b32 s42, s18, 1
    s_add_u32 s42, s42, s40
    s_mul_i32 s42, s42, 69632
    s_lshl_b32 s43, s41, 10
    s_add_u32 s43, s43, s42
    v_add_u32 v3, s43, v2
    v_lshrrev_b32 v4, 2, v1
    s_mov_b32 s43, 4352
    v_mul_lo_u32 v4, v4, s43
    v_and_b32 v6, 3, v1
    v_lshl_add_u32 v4, v6, 3, v4
    s_lshl_b32 s43, s41, 5
    s_add_u32 s43, s43, s42
    s_add_u32 s43, s43, 4096
    v_add_u32 v4, s43, v4
    buffer_load_dwordx2 v[10:11], v4, s[52:55], 0 offen
    buffer_load_dwordx2 v[12:13], v4, s[52:55], 0 offen offset:64
    s_mov_b32 s43, 0
    buffer_load_dwordx4 v[32:35], v3, s[52:55], s43 offen
    buffer_load_dwordx4 v[36:39], v3, s[52:55], s43 offen offset:2048
    s_add_u32 s43, s43, 4352
    buffer_load_dwordx4 v[40:43], v3, s[52:55], s43 offen
    buffer_load_dwordx4 v[44:47], v3, s[52:55], s43 offen offset:2048
    s_add_u32 s43, s43, 4352
    buffer_load_dwordx4 v[48:51], v3, s[52:55], s43 offen
    buffer_load_dwordx4 v[52:55], v3, s[52:55], s43 offen offset:2048
    s_add_u32 s43, s43, 4352
    buffer_load_dwordx4 v[56:59], v3, s[52:55], s43 offen
    buffer_load_dwordx4 v[60:63], v3, s[52:55], s43 offen offset:2048
    s_add_u32 s43, s43, 4352
    buffer_load_dwordx4 v[64:67], v3, s[52:55], s43 offen
    buffer_load_dwordx4 v[68:71], v3, s[52:55], s43 offen offset:2048
    s_add_u32 s43, s43, 4352
    buffer_load_dwordx4 v[72:75], v3, s[52:55], s43 offen
    buffer_load_dwordx4 v[76:79], v3, s[52:55], s43 offen offset:2048
    s_add_u32 s43, s43, 4352
    buffer_load_dwordx4 v[80:83], v3, s[52:55], s43 offen
    buffer_load_dwordx4 v[84:87], v3, s[52:55], s43 offen offset:2048
    s_add_u32 s43, s43, 4352
    buffer_load_dwordx4 v[88:91], v3, s[52:55], s43 offen
    buffer_load_dwordx4 v[92:95], v3, s[52:55], s43 offen offset:2048
    s_add_u32 s43, s43, 4352
    buffer_load_dwordx4 v[96:99], v3, s[52:55], s43 offen
    buffer_load_dwordx4 v[100:103], v3, s[52:55], s43 offen offset:2048
    s_add_u32 s43, s43, 4352
    buffer_load_dwordx4 v[104:107], v3, s[52:55], s43 offen
    buffer_load_dwordx4 v[108:111], v3, s[52:55], s43 offen offset:2048
    s_add_u32 s43, s43, 4352
    buffer_load_dwordx4 v[112:115], v3, s[52:55], s43 offen
    buffer_load_dwordx4 v[116:119], v3, s[52:55], s43 offen offset:2048
    s_add_u32 s43, s43, 4352
    buffer_load_dwordx4 v[120:123], v3, s[52:55], s43 offen
    buffer_load_dwordx4 v[124:127], v3, s[52:55], s43 offen offset:2048
    s_add_u32 s43, s43, 4352
    buffer_load_dwordx4 v[128:131], v3, s[52:55], s43 offen
    buffer_load_dwordx4 v[132:135], v3, s[52:55], s43 offen offset:2048
    s_add_u32 s43, s43, 4352
    buffer_load_dwordx4 v[136:139], v3, s[52:55], s43 offen
    buffer_load_dwordx4 v[140:143], v3, s[52:55], s43 offen offset:2048
    s_add_u32 s43, s43, 4352
    buffer_load_dwordx4 v[144:147], v3, s[52:55], s43 offen
    buffer_load_dwordx4 v[148:151], v3, s[52:55], s43 offen offset:2048
    s_add_u32 s43, s43, 4352
    buffer_load_dwordx4 v[152:155], v3, s[52:55], s43 offen
    buffer_load_dwordx4 v[156:159], v3, s[52:55], s43 offen offset:2048
    v_lshrrev_b32 v5, 4, v1
    v_bfe_u32 v6, v1, 2, 2
    v_cmp_eq_u32 vcc, v5, v6
    v_and_b32 v5, 1, v1
    v_lshlrev_b32 v5, 4, v5
    v_mov_b32 v6, 0x3f80
    v_lshlrev_b32 v6, v5, v6
    v_cndmask_b32 v6, 0, v6, vcc
    v_and_b32 v5, 2, v1
    v_cmp_eq_u32 vcc, 0, v5
    s_nop 1
    v_cndmask_b32 v160, 0, v6, vcc
    v_mov_b32 v7, 0
    v_cndmask_b32 v160, v7, v6, vcc
    v_cndmask_b32 v161, v6, v7, vcc
    v_mov_b32 v162, 0
    v_mov_b32 v163, 0
    v_mov_b32 v164, 0
    v_mov_b32 v165, 0
    v_mov_b32 v166, v160
    v_mov_b32 v167, v161
    s_waitcnt vmcnt(32)
    v_lshlrev_b32 v16, 16, v10
    v_and_b32 v17, 0xffff0000, v10
    v_lshlrev_b32 v18, 16, v11
    v_and_b32 v19, 0xffff0000, v11
    v_lshlrev_b32 v20, 16, v12
    v_and_b32 v21, 0xffff0000, v12
    v_lshlrev_b32 v22, 16, v13
    v_and_b32 v23, 0xffff0000, v13
    v_add_f32_dpp v16, v16, v16 row_ror:4 row_mask:0xf bank_mask:0xf
    v_add_f32_dpp v17, v17, v17 row_ror:4 row_mask:0xf bank_mask:0xf
    v_add_f32_dpp v18, v18, v18 row_ror:4 row_mask:0xf bank_mask:0xf
    v_add_f32_dpp v19, v19, v19 row_ror:4 row_mask:0xf bank_mask:0xf
    v_add_f32_dpp v20, v20, v20 row_ror:4 row_mask:0xf bank_mask:0xf
    v_add_f32_dpp v21, v21, v21 row_ror:4 row_mask:0xf bank_mask:0xf
    v_add_f32_dpp v22, v22, v22 row_ror:4 row_mask:0xf bank_mask:0xf
    v_add_f32_dpp v23, v23, v23 row_ror:4 row_mask:0xf bank_mask:0xf
    v_add_f32_dpp v16, v16, v16 row_ror:8 row_mask:0xf bank_mask:0xf
    v_add_f32_dpp v17, v17, v17 row_ror:8 row_mask:0xf bank_mask:0xf
    v_add_f32_dpp v18, v18, v18 row_ror:8 row_mask:0xf bank_mask:0xf
    v_add_f32_dpp v19, v19, v19 row_ror:8 row_mask:0xf bank_mask:0xf
    v_add_f32_dpp v20, v20, v20 row_ror:8 row_mask:0xf bank_mask:0xf
    v_add_f32_dpp v21, v21, v21 row_ror:8 row_mask:0xf bank_mask:0xf
    v_add_f32_dpp v22, v22, v22 row_ror:8 row_mask:0xf bank_mask:0xf
    v_add_f32_dpp v23, v23, v23 row_ror:8 row_mask:0xf bank_mask:0xf
    v_permlane32_swap_b32 v16, v17
    v_permlane32_swap_b32 v18, v19
    v_add_f32 v16, v16, v17
    v_add_f32 v18, v18, v19
    s_nop 1
    v_permlane16_swap_b32 v16, v18
    v_add_f32 v16, v16, v18
    v_mov_b32 v18, v16
    s_nop 1
    v_permlane16_swap_b32 v16, v18
    v_mov_b32 v17, v16
    v_mov_b32 v19, v18
    s_nop 0
    v_permlane32_swap_b32 v16, v17
    v_permlane32_swap_b32 v18, v19
    v_permlane32_swap_b32 v20, v21
    v_permlane32_swap_b32 v22, v23
    v_add_f32 v20, v20, v21
    v_add_f32 v22, v22, v23
    s_nop 1
    v_permlane16_swap_b32 v20, v22
    v_add_f32 v20, v20, v22
    v_mov_b32 v22, v20
    s_nop 1
    v_permlane16_swap_b32 v20, v22
    v_mov_b32 v21, v20
    v_mov_b32 v23, v22
    s_nop 0
    v_permlane32_swap_b32 v20, v21
    v_permlane32_swap_b32 v22, v23
    v_cvt_pk_bf16_f32 v10, v16, v17
    v_cvt_pk_bf16_f32 v11, v18, v19
    v_cvt_pk_bf16_f32 v12, v20, v21
    v_cvt_pk_bf16_f32 v13, v22, v23
    v_and_b32 v6, 3, v1
    v_lshlrev_b32 v6, 3, v6
    s_lshl_b32 s43, s41, 5
    s_lshl_b32 s45, s40, 13
    s_add_u32 s43, s43, s45
    s_add_u32 s43, s43, 143360
    v_add_u32 v6, s43, v6
    ds_write_b64 v6, v[10:11]
    ds_write_b64 v6, v[12:13] offset:64
    s_waitcnt vmcnt(28)
    v_mfma_f32_16x16x32_bf16 v[168:171], v[160:163], v[32:35], 0
    v_mfma_f32_16x16x32_bf16 v[172:175], v[164:167], v[32:35], 0
    v_mfma_f32_16x16x32_bf16 v[176:179], v[160:163], v[36:39], 0
    v_mfma_f32_16x16x32_bf16 v[180:183], v[164:167], v[36:39], 0
    v_mfma_f32_16x16x32_bf16 v[168:171], v[160:163], v[40:43], v[168:171]
    v_mfma_f32_16x16x32_bf16 v[172:175], v[164:167], v[40:43], v[172:175]
    v_mfma_f32_16x16x32_bf16 v[176:179], v[160:163], v[44:47], v[176:179]
    v_mfma_f32_16x16x32_bf16 v[180:183], v[164:167], v[44:47], v[180:183]
    s_waitcnt vmcnt(24)
    v_mfma_f32_16x16x32_bf16 v[168:171], v[160:163], v[48:51], v[168:171]
    v_mfma_f32_16x16x32_bf16 v[172:175], v[164:167], v[48:51], v[172:175]
    v_mfma_f32_16x16x32_bf16 v[176:179], v[160:163], v[52:55], v[176:179]
    v_mfma_f32_16x16x32_bf16 v[180:183], v[164:167], v[52:55], v[180:183]
    v_mfma_f32_16x16x32_bf16 v[168:171], v[160:163], v[56:59], v[168:171]
    v_mfma_f32_16x16x32_bf16 v[172:175], v[164:167], v[56:59], v[172:175]
    v_mfma_f32_16x16x32_bf16 v[176:179], v[160:163], v[60:63], v[176:179]
    v_mfma_f32_16x16x32_bf16 v[180:183], v[164:167], v[60:63], v[180:183]
    s_waitcnt vmcnt(20)
    v_mfma_f32_16x16x32_bf16 v[168:171], v[160:163], v[64:67], v[168:171]
    v_mfma_f32_16x16x32_bf16 v[172:175], v[164:167], v[64:67], v[172:175]
    v_mfma_f32_16x16x32_bf16 v[176:179], v[160:163], v[68:71], v[176:179]
    v_mfma_f32_16x16x32_bf16 v[180:183], v[164:167], v[68:71], v[180:183]
    v_mfma_f32_16x16x32_bf16 v[168:171], v[160:163], v[72:75], v[168:171]
    v_mfma_f32_16x16x32_bf16 v[172:175], v[164:167], v[72:75], v[172:175]
    v_mfma_f32_16x16x32_bf16 v[176:179], v[160:163], v[76:79], v[176:179]
    v_mfma_f32_16x16x32_bf16 v[180:183], v[164:167], v[76:79], v[180:183]
    s_waitcnt vmcnt(16)
    v_mfma_f32_16x16x32_bf16 v[168:171], v[160:163], v[80:83], v[168:171]
    v_mfma_f32_16x16x32_bf16 v[172:175], v[164:167], v[80:83], v[172:175]
    v_mfma_f32_16x16x32_bf16 v[176:179], v[160:163], v[84:87], v[176:179]
    v_mfma_f32_16x16x32_bf16 v[180:183], v[164:167], v[84:87], v[180:183]
    v_mfma_f32_16x16x32_bf16 v[168:171], v[160:163], v[88:91], v[168:171]
    v_mfma_f32_16x16x32_bf16 v[172:175], v[164:167], v[88:91], v[172:175]
    v_mfma_f32_16x16x32_bf16 v[176:179], v[160:163], v[92:95], v[176:179]
    v_mfma_f32_16x16x32_bf16 v[180:183], v[164:167], v[92:95], v[180:183]
    s_waitcnt vmcnt(12)
    v_mfma_f32_16x16x32_bf16 v[168:171], v[160:163], v[96:99], v[168:171]
    v_mfma_f32_16x16x32_bf16 v[172:175], v[164:167], v[96:99], v[172:175]
    v_mfma_f32_16x16x32_bf16 v[176:179], v[160:163], v[100:103], v[176:179]
    v_mfma_f32_16x16x32_bf16 v[180:183], v[164:167], v[100:103], v[180:183]
    v_mfma_f32_16x16x32_bf16 v[168:171], v[160:163], v[104:107], v[168:171]
    v_mfma_f32_16x16x32_bf16 v[172:175], v[164:167], v[104:107], v[172:175]
    v_mfma_f32_16x16x32_bf16 v[176:179], v[160:163], v[108:111], v[176:179]
    v_mfma_f32_16x16x32_bf16 v[180:183], v[164:167], v[108:111], v[180:183]
    s_waitcnt vmcnt(8)
    v_mfma_f32_16x16x32_bf16 v[168:171], v[160:163], v[112:115], v[168:171]
    v_mfma_f32_16x16x32_bf16 v[172:175], v[164:167], v[112:115], v[172:175]
    v_mfma_f32_16x16x32_bf16 v[176:179], v[160:163], v[116:119], v[176:179]
    v_mfma_f32_16x16x32_bf16 v[180:183], v[164:167], v[116:119], v[180:183]
    v_mfma_f32_16x16x32_bf16 v[168:171], v[160:163], v[120:123], v[168:171]
    v_mfma_f32_16x16x32_bf16 v[172:175], v[164:167], v[120:123], v[172:175]
    v_mfma_f32_16x16x32_bf16 v[176:179], v[160:163], v[124:127], v[176:179]
    v_mfma_f32_16x16x32_bf16 v[180:183], v[164:167], v[124:127], v[180:183]
    s_waitcnt vmcnt(4)
    v_mfma_f32_16x16x32_bf16 v[168:171], v[160:163], v[128:131], v[168:171]
    v_mfma_f32_16x16x32_bf16 v[172:175], v[164:167], v[128:131], v[172:175]
    v_mfma_f32_16x16x32_bf16 v[176:179], v[160:163], v[132:135], v[176:179]
    v_mfma_f32_16x16x32_bf16 v[180:183], v[164:167], v[132:135], v[180:183]
    v_mfma_f32_16x16x32_bf16 v[168:171], v[160:163], v[136:139], v[168:171]
    v_mfma_f32_16x16x32_bf16 v[172:175], v[164:167], v[136:139], v[172:175]
    v_mfma_f32_16x16x32_bf16 v[176:179], v[160:163], v[140:143], v[176:179]
    v_mfma_f32_16x16x32_bf16 v[180:183], v[164:167], v[140:143], v[180:183]
    s_waitcnt vmcnt(0)
    v_mfma_f32_16x16x32_bf16 v[168:171], v[160:163], v[144:147], v[168:171]
    v_mfma_f32_16x16x32_bf16 v[172:175], v[164:167], v[144:147], v[172:175]
    v_mfma_f32_16x16x32_bf16 v[176:179], v[160:163], v[148:151], v[176:179]
    v_mfma_f32_16x16x32_bf16 v[180:183], v[164:167], v[148:151], v[180:183]
    v_mfma_f32_16x16x32_bf16 v[168:171], v[160:163], v[152:155], v[168:171]
    v_mfma_f32_16x16x32_bf16 v[172:175], v[164:167], v[152:155], v[172:175]
    v_mfma_f32_16x16x32_bf16 v[176:179], v[160:163], v[156:159], v[176:179]
    v_mfma_f32_16x16x32_bf16 v[180:183], v[164:167], v[156:159], v[180:183]
    v_lshlrev_b32 v6, 3, v1
    s_lshl_b32 s43, s41, 9
    s_add_u32 s43, s43, s45
    s_add_u32 s43, s43, 139264
    v_add_u32 v7, s43, v6
    v_cvt_pk_bf16_f32 v28, v168, v169
    v_cvt_pk_bf16_f32 v29, v170, v171
    ds_write_b64 v7, v[28:29] offset:0
    v_cvt_pk_bf16_f32 v28, v172, v173
    v_cvt_pk_bf16_f32 v29, v174, v175
    ds_write_b64 v7, v[28:29] offset:2048
    v_cvt_pk_bf16_f32 v28, v176, v177
    v_cvt_pk_bf16_f32 v29, v178, v179
    ds_write_b64 v7, v[28:29] offset:1024
    v_cvt_pk_bf16_f32 v28, v180, v181
    v_cvt_pk_bf16_f32 v29, v182, v183
    ds_write_b64 v7, v[28:29] offset:3072
    s_waitcnt lgkmcnt(0)
    s_barrier
    s_mov_b32 s8, s60
    s_mov_b32 s9, s61
    s_mov_b32 s10, 0x200000
    s_mov_b32 s11, 0x20000
    v_lshrrev_b32 v7, 3, v1
    v_lshlrev_b32 v7, 11, v7
    v_bfe_u32 v8, v1, 4, 2
    v_lshlrev_b32 v8, 1, v8
    v_and_b32 v9, 7, v1
    v_xor_b32 v8, v8, v9
    v_lshl_add_u32 v7, v8, 4, v7
    s_lshl_b32 s43, s49, 15
    s_lshl_b32 s45, s31, 7
    s_add_u32 s43, s43, s45
    v_add_u32 v7, s43, v7
    v_add_u32 v8, 15360, v7
    s_lshl_b32 s45, s49, 11
    s_mov_b32 s43, 0
    s_add_u32 m0, s45, 0
    s_nop 0
    buffer_load_dwordx4 v7, s[8:11], s43 offen lds
    buffer_load_dwordx4 v8, s[8:11], s43 offen offset:1024 lds
    s_mov_b32 s43, 131072
    s_add_u32 m0, s45, 8192
    s_nop 0
    buffer_load_dwordx4 v7, s[8:11], s43 offen lds
    buffer_load_dwordx4 v8, s[8:11], s43 offen offset:1024 lds
    s_mov_b32 s43, 262144
    s_add_u32 m0, s45, 16384
    s_nop 0
    buffer_load_dwordx4 v7, s[8:11], s43 offen lds
    buffer_load_dwordx4 v8, s[8:11], s43 offen offset:1024 lds
    s_mov_b32 s43, 393216
    s_add_u32 m0, s45, 24576
    s_nop 0
    buffer_load_dwordx4 v7, s[8:11], s43 offen lds
    buffer_load_dwordx4 v8, s[8:11], s43 offen offset:1024 lds
    s_mov_b32 s43, 1966080
    s_add_u32 m0, s45, 122880
    s_nop 0
    buffer_load_dwordx4 v7, s[8:11], s43 offen lds
    buffer_load_dwordx4 v8, s[8:11], s43 offen offset:1024 lds
    s_waitcnt vmcnt(0)
    s_add_u32 s12, s34, 0x1400000
    s_addc_u32 s13, s35, 0
    s_mov_b32 s14, 0x400000
    s_mov_b32 s15, 0x20000
    s_barrier
    s_branch KA_pre7
KA_redc:
    s_barrier
    v_lshlrev_b32 v6, 3, v1
    s_lshl_b32 s43, s39, 13
    s_add_u32 s43, s43, 139264
    v_add_u32 v6, s43, v6
    ds_read_b64 v[32:33], v6 offset:0
    ds_read_b64 v[34:35], v6 offset:512
    ds_read_b64 v[36:37], v6 offset:1024
    ds_read_b64 v[38:39], v6 offset:1536
    ds_read_b64 v[40:41], v6 offset:2048
    ds_read_b64 v[42:43], v6 offset:2560
    ds_read_b64 v[44:45], v6 offset:3072
    ds_read_b64 v[46:47], v6 offset:3584
    v_lshrrev_b32 v7, 4, v1
    v_lshlrev_b32 v7, 3, v7
    v_add_u32 v7, s43, v7
    ds_read_b64 v[48:49], v7 offset:4096
    ds_read_b64 v[50:51], v7 offset:4128
    ds_read_b64 v[52:53], v7 offset:4160
    ds_read_b64 v[54:55], v7 offset:4192
    v_mov_b32 v56, 0x3f803f80
    v_mov_b32 v57, 0x3f803f80
    v_mov_b32 v58, 0x3f803f80
    v_mov_b32 v59, 0x3f803f80
    s_waitcnt lgkmcnt(0)
    v_mfma_f32_16x16x32_bf16 v[64:67], v[32:35], v[208:211], 0
    v_mfma_f32_16x16x32_bf16 v[68:71], v[40:43], v[208:211], 0
    v_mfma_f32_16x16x32_bf16 v[80:83], v[48:51], v[208:211], 0
    v_mfma_f32_16x16x32_bf16 v[88:91], v[56:59], v[208:211], 0
    v_mfma_f32_16x16x32_bf16 v[72:75], v[36:39], v[212:215], 0
    v_mfma_f32_16x16x32_bf16 v[76:79], v[44:47], v[212:215], 0
    v_mfma_f32_16x16x32_bf16 v[84:87], v[52:55], v[212:215], 0
    v_mfma_f32_16x16x32_bf16 v[92:95], v[56:59], v[212:215], 0
    v_mfma_f32_16x16x32_bf16 v[96:99], v[32:35], v[216:219], 0
    v_mfma_f32_16x16x32_bf16 v[100:103], v[40:43], v[216:219], 0
    v_mfma_f32_16x16x32_bf16 v[112:115], v[48:51], v[216:219], 0
    v_mfma_f32_16x16x32_bf16 v[120:123], v[56:59], v[216:219], 0
    v_mfma_f32_16x16x32_bf16 v[104:107], v[36:39], v[220:223], 0
    v_mfma_f32_16x16x32_bf16 v[108:111], v[44:47], v[220:223], 0
    v_mfma_f32_16x16x32_bf16 v[116:119], v[52:55], v[220:223], 0
    v_mfma_f32_16x16x32_bf16 v[124:127], v[56:59], v[220:223], 0
    v_mfma_f32_16x16x32_bf16 v[128:131], v[32:35], v[224:227], 0
    v_mfma_f32_16x16x32_bf16 v[132:135], v[40:43], v[224:227], 0
    v_mfma_f32_16x16x32_bf16 v[144:147], v[48:51], v[224:227], 0
    v_mfma_f32_16x16x32_bf16 v[152:155], v[56:59], v[224:227], 0
    v_mfma_f32_16x16x32_bf16 v[136:139], v[36:39], v[228:231], 0
    v_mfma_f32_16x16x32_bf16 v[140:143], v[44:47], v[228:231], 0
    v_mfma_f32_16x16x32_bf16 v[148:151], v[52:55], v[228:231], 0
    v_mfma_f32_16x16x32_bf16 v[156:159], v[56:59], v[228:231], 0
    v_mfma_f32_16x16x32_bf16 v[160:163], v[32:35], v[232:235], 0
    v_mfma_f32_16x16x32_bf16 v[164:167], v[40:43], v[232:235], 0
    v_mfma_f32_16x16x32_bf16 v[176:179], v[48:51], v[232:235], 0
    v_mfma_f32_16x16x32_bf16 v[184:187], v[56:59], v[232:235], 0
    v_mfma_f32_16x16x32_bf16 v[168:171], v[36:39], v[236:239], 0
    v_mfma_f32_16x16x32_bf16 v[172:175], v[44:47], v[236:239], 0
    v_mfma_f32_16x16x32_bf16 v[180:183], v[52:55], v[236:239], 0
    v_mfma_f32_16x16x32_bf16 v[188:191], v[56:59], v[236:239], 0
    s_add_u32 s12, s34, 0x1400000
    s_addc_u32 s13, s35, 0
    s_mov_b32 s14, 0x400000
    s_mov_b32 s15, 0x20000
    s_lshl_b32 s40, s38, 2
    s_add_u32 s40, s40, s44
    s_lshl_b32 s40, s40, 5
    s_lshl_b32 s41, s18, 1
    s_add_u32 s41, s41, s39
    s_add_u32 s40, s40, s41
    s_lshl_b32 s40, s40, 10
    v_add_u32 v5, s40, v2
    v_xor_b32 v8, 1024, v5
    v_rcp_f32 v88, v88
    v_rcp_f32 v92, v92
    v_rcp_f32 v120, v120
    v_rcp_f32 v124, v124
    v_rcp_f32 v152, v152
    v_rcp_f32 v156, v156
    v_rcp_f32 v184, v184
    v_rcp_f32 v188, v188
    v_mul_f32 v80, v80, v88
    v_fma_f32 v80, v84, v92, v80
    v_add_f32 v80, 0x358637bd, v80
    v_mul_f32 v112, v112, v120
    v_fma_f32 v112, v116, v124, v112
    v_add_f32 v112, 0x358637bd, v112
    v_mul_f32 v144, v144, v152
    v_fma_f32 v144, v148, v156, v144
    v_add_f32 v144, 0x358637bd, v144
    v_mul_f32 v176, v176, v184
    v_fma_f32 v176, v180, v188, v176
    v_add_f32 v176, 0x358637bd, v176
    v_rcp_f32 v80, v80
    v_rcp_f32 v112, v112
    v_rcp_f32 v144, v144
    v_rcp_f32 v176, v176
    v_mul_f32 v88, v88, v80
    v_mul_f32 v92, v92, v80
    v_mul_f32 v120, v120, v112
    v_mul_f32 v124, v124, v112
    v_mul_f32 v152, v152, v144
    v_mul_f32 v156, v156, v144
    v_mul_f32 v184, v184, v176
    v_mul_f32 v188, v188, v176
    s_mov_b32 s43, 0
    v_pk_mul_f32 v[64:65], v[64:65], v[88:89] op_sel_hi:[1,0]
    v_pk_mul_f32 v[66:67], v[66:67], v[88:89] op_sel_hi:[1,0]
    v_pk_mul_f32 v[68:69], v[68:69], v[88:89] op_sel_hi:[1,0]
    v_pk_mul_f32 v[70:71], v[70:71], v[88:89] op_sel_hi:[1,0]
    v_pk_fma_f32 v[64:65], v[72:73], v[92:93], v[64:65] op_sel_hi:[1,0,1]
    v_pk_fma_f32 v[66:67], v[74:75], v[92:93], v[66:67] op_sel_hi:[1,0,1]
    v_pk_fma_f32 v[68:69], v[76:77], v[92:93], v[68:69] op_sel_hi:[1,0,1]
    v_pk_fma_f32 v[70:71], v[78:79], v[92:93], v[70:71] op_sel_hi:[1,0,1]
    v_cvt_pk_bf16_f32 v16, v64, v65
    v_cvt_pk_bf16_f32 v17, v66, v67
    v_cvt_pk_bf16_f32 v18, v68, v69
    v_cvt_pk_bf16_f32 v19, v70, v71
    buffer_store_dwordx4 v[16:19], v5, s[12:15], s43 offen sc1
    s_add_u32 s43, s43, 32768
    v_pk_mul_f32 v[96:97], v[96:97], v[120:121] op_sel_hi:[1,0]
    v_pk_mul_f32 v[98:99], v[98:99], v[120:121] op_sel_hi:[1,0]
    v_pk_mul_f32 v[100:101], v[100:101], v[120:121] op_sel_hi:[1,0]
    v_pk_mul_f32 v[102:103], v[102:103], v[120:121] op_sel_hi:[1,0]
    v_pk_fma_f32 v[96:97], v[104:105], v[124:125], v[96:97] op_sel_hi:[1,0,1]
    v_pk_fma_f32 v[98:99], v[106:107], v[124:125], v[98:99] op_sel_hi:[1,0,1]
    v_pk_fma_f32 v[100:101], v[108:109], v[124:125], v[100:101] op_sel_hi:[1,0,1]
    v_pk_fma_f32 v[102:103], v[110:111], v[124:125], v[102:103] op_sel_hi:[1,0,1]
    v_cvt_pk_bf16_f32 v20, v96, v97
    v_cvt_pk_bf16_f32 v21, v98, v99
    v_cvt_pk_bf16_f32 v22, v100, v101
    v_cvt_pk_bf16_f32 v23, v102, v103
    buffer_store_dwordx4 v[20:23], v8, s[12:15], s43 offen sc1
    s_add_u32 s43, s43, 32768
    v_pk_mul_f32 v[128:129], v[128:129], v[152:153] op_sel_hi:[1,0]
    v_pk_mul_f32 v[130:131], v[130:131], v[152:153] op_sel_hi:[1,0]
    v_pk_mul_f32 v[132:133], v[132:133], v[152:153] op_sel_hi:[1,0]
    v_pk_mul_f32 v[134:135], v[134:135], v[152:153] op_sel_hi:[1,0]
    v_pk_fma_f32 v[128:129], v[136:137], v[156:157], v[128:129] op_sel_hi:[1,0,1]
    v_pk_fma_f32 v[130:131], v[138:139], v[156:157], v[130:131] op_sel_hi:[1,0,1]
    v_pk_fma_f32 v[132:133], v[140:141], v[156:157], v[132:133] op_sel_hi:[1,0,1]
    v_pk_fma_f32 v[134:135], v[142:143], v[156:157], v[134:135] op_sel_hi:[1,0,1]
    v_cvt_pk_bf16_f32 v24, v128, v129
    v_cvt_pk_bf16_f32 v25, v130, v131
    v_cvt_pk_bf16_f32 v26, v132, v133
    v_cvt_pk_bf16_f32 v27, v134, v135
    buffer_store_dwordx4 v[24:27], v5, s[12:15], s43 offen sc1
    s_add_u32 s43, s43, 32768
    v_pk_mul_f32 v[160:161], v[160:161], v[184:185] op_sel_hi:[1,0]
    v_pk_mul_f32 v[162:163], v[162:163], v[184:185] op_sel_hi:[1,0]
    v_pk_mul_f32 v[164:165], v[164:165], v[184:185] op_sel_hi:[1,0]
    v_pk_mul_f32 v[166:167], v[166:167], v[184:185] op_sel_hi:[1,0]
    v_pk_fma_f32 v[160:161], v[168:169], v[188:189], v[160:161] op_sel_hi:[1,0,1]
    v_pk_fma_f32 v[162:163], v[170:171], v[188:189], v[162:163] op_sel_hi:[1,0,1]
    v_pk_fma_f32 v[164:165], v[172:173], v[188:189], v[164:165] op_sel_hi:[1,0,1]
    v_pk_fma_f32 v[166:167], v[174:175], v[188:189], v[166:167] op_sel_hi:[1,0,1]
    v_cvt_pk_bf16_f32 v28, v160, v161
    v_cvt_pk_bf16_f32 v29, v162, v163
    v_cvt_pk_bf16_f32 v30, v164, v165
    v_cvt_pk_bf16_f32 v31, v166, v167
    buffer_store_dwordx4 v[28:31], v8, s[12:15], s43 offen sc1
    s_waitcnt vmcnt(0)
    s_barrier
KA_pre7:
    s_mov_b32 s17, s30
    s_mov_b32 s18, s31
    s_lshl_b32 s44, s30, 3
    s_and_b32 s38, s16, 3
    s_lshr_b32 s39, s16, 2
    s_lshl_b32 s46, s38, 1
    s_add_u32 s46, s46, s39
    s_mov_b32 s8, s64
    s_mov_b32 s9, s65
    s_mov_b32 s10, 0x400000
    s_mov_b32 s11, 0x20000
    s_lshl_b32 s40, s17, 7
    s_lshl_b32 s41, s46, 4
    s_add_u32 s40, s40, s41
    v_and_b32 v9, 15, v1
    v_add_u32 v241, s40, v9
    v_lshlrev_b32 v9, 11, v241
    s_lshl_b32 s41, s18, 7
    v_lshrrev_b32 v10, 4, v1
    v_lshl_add_u32 v9, v10, 3, v9
    v_add_u32 v9, s41, v9
    s_cmp_lg_u32 s16, 0
    s_cbranch_scc1 KA_nopoll2
    v_mov_b32 v40, 1
    v_mov_b32 v41, 0
    s_mov_b64 s[78:79], exec
    s_mov_b64 exec, 1
    buffer_atomic_add v40, v41, s[56:59], s51 offen
    s_mov_b64 exec, s[78:79]
    s_mov_b32 s77, 0x40000
    v_mov_b32 v41, 0
KA_p2:
    buffer_load_dword v40, v41, s[56:59], s29 offen sc1
    s_waitcnt vmcnt(0)
    v_readfirstlane_b32 s78, v40
    s_nop 3
    s_cmp_ge_u32 s78, 16
    s_cbranch_scc1 KA_p2_done
    s_sleep 1
    s_sub_u32 s77, s77, 1
    s_cmp_lg_u32 s77, 0
    s_cbranch_scc1 KA_p2
KA_p2_done:
KA_nopoll2:
    s_barrier
    s_lshl_b32 s40, s38, 1
    s_add_u32 s40, s40, s44
    s_lshl_b32 s40, s40, 15
    v_add_u32 v3, s40, v2
    v_add_u32 v4, 32768, v3
    v_bfe_u32 v14, v1, 1, 1
    v_bfe_u32 v15, v1, 3, 2
    v_lshlrev_b32 v15, 1, v15
    v_xor_b32 v14, v14, v15
    v_lshrrev_b32 v15, 2, v1
    v_lshlrev_b32 v5, 7, v15
    v_lshl_add_u32 v5, v14, 4, v5
    v_and_b32 v15, 1, v1
    v_lshl_add_u32 v5, v15, 3, v5
    v_xor_b32 v6, 32, v5
    v_xor_b32 v7, 64, v5
    v_xor_b32 v8, 96, v5
    s_and_b32 s43, s18, 3
    s_lshl_b32 s43, s43, 3
    s_lshl_b32 s41, s39, 4
    s_add_u32 s43, s43, s41
    s_and_b32 s43, s43, 31
    s_lshl_b32 s43, s43, 10
    s_lshl_b32 s41, s43, 2
    v_add_u32 v5, s41, v5
    v_add_u32 v6, s41, v6
    v_add_u32 v7, s41, v7
    v_add_u32 v8, s41, v8
    s_xor_b32 s42, s43, 1024
    buffer_load_dwordx4 v[16:19], v3, s[12:15], s43 offen
    buffer_load_dwordx4 v[20:23], v4, s[12:15], s42 offen
    s_add_u32 s43, s43, 1024
    s_and_b32 s43, s43, 0x7fff
    s_xor_b32 s42, s43, 1024
    buffer_load_dwordx4 v[24:27], v3, s[12:15], s43 offen
    buffer_load_dwordx4 v[28:31], v4, s[12:15], s42 offen
    s_add_u32 s43, s43, 1024
    s_and_b32 s43, s43, 0x7fff
    s_xor_b32 s42, s43, 1024
    buffer_load_dwordx4 v[32:35], v3, s[12:15], s43 offen
    buffer_load_dwordx4 v[36:39], v4, s[12:15], s42 offen
    s_add_u32 s43, s43, 1024
    s_and_b32 s43, s43, 0x7fff
    s_xor_b32 s42, s43, 1024
    buffer_load_dwordx4 v[40:43], v3, s[12:15], s43 offen
    buffer_load_dwordx4 v[44:47], v4, s[12:15], s42 offen
    s_add_u32 s43, s43, 1024
    s_and_b32 s43, s43, 0x7fff
    s_xor_b32 s42, s43, 1024
    v_mov_b32 v176, 0
    v_mov_b32 v177, 0
    v_mov_b32 v178, 0
    v_mov_b32 v179, 0
    v_mov_b32 v180, 0
    v_mov_b32 v181, 0
    v_mov_b32 v182, 0
    v_mov_b32 v183, 0
    v_mov_b32 v184, 0
    v_mov_b32 v185, 0
    v_mov_b32 v186, 0
    v_mov_b32 v187, 0
    v_mov_b32 v188, 0
    v_mov_b32 v189, 0
    v_mov_b32 v190, 0
    v_mov_b32 v191, 0
    v_mov_b32 v192, 0
    v_mov_b32 v193, 0
    v_mov_b32 v194, 0
    v_mov_b32 v195, 0
    v_mov_b32 v196, 0
    v_mov_b32 v197, 0
    v_mov_b32 v198, 0
    v_mov_b32 v199, 0
    v_mov_b32 v200, 0
    v_mov_b32 v201, 0
    v_mov_b32 v202, 0
    v_mov_b32 v203, 0
    v_mov_b32 v204, 0
    v_mov_b32 v205, 0
    v_mov_b32 v206, 0
    v_mov_b32 v207, 0
    ds_read_b64_tr_b16 v[80:81], v5 offset:0
    ds_read_b64_tr_b16 v[82:83], v5 offset:2048
    ds_read_b64_tr_b16 v[84:85], v6 offset:0
    ds_read_b64_tr_b16 v[86:87], v6 offset:2048
    ds_read_b64_tr_b16 v[88:89], v7 offset:0
    ds_read_b64_tr_b16 v[90:91], v7 offset:2048
    ds_read_b64_tr_b16 v[92:93], v8 offset:0
    ds_read_b64_tr_b16 v[94:95], v8 offset:2048
    s_mov_b32 s47, 3
KA_gloop:
    s_waitcnt vmcnt(6)
    s_waitcnt lgkmcnt(6)
    v_mfma_f32_16x16x32_bf16 v[176:179], v[80:83], v[16:19], v[176:179]
    ds_read_b64_tr_b16 v[96:97], v5 offset:4096
    v_mfma_f32_16x16x32_bf16 v[192:195], v[80:83], v[20:23], v[192:195]
    ds_read_b64_tr_b16 v[98:99], v5 offset:6144
    s_waitcnt lgkmcnt(6)
    v_mfma_f32_16x16x32_bf16 v[180:183], v[84:87], v[16:19], v[180:183]
    ds_read_b64_tr_b16 v[100:101], v6 offset:4096
    v_mfma_f32_16x16x32_bf16 v[196:199], v[84:87], v[20:23], v[196:199]
    ds_read_b64_tr_b16 v[102:103], v6 offset:6144
    s_waitcnt lgkmcnt(6)
    v_mfma_f32_16x16x32_bf16 v[184:187], v[88:91], v[16:19], v[184:187]
    ds_read_b64_tr_b16 v[104:105], v7 offset:4096
    v_mfma_f32_16x16x32_bf16 v[200:203], v[88:91], v[20:23], v[200:203]
    ds_read_b64_tr_b16 v[106:107], v7 offset:6144
    s_waitcnt lgkmcnt(6)
    v_mfma_f32_16x16x32_bf16 v[188:191], v[92:95], v[16:19], v[188:191]
    ds_read_b64_tr_b16 v[108:109], v8 offset:4096
    v_mfma_f32_16x16x32_bf16 v[204:207], v[92:95], v[20:23], v[204:207]
    ds_read_b64_tr_b16 v[110:111], v8 offset:6144
    buffer_load_dwordx4 v[16:19], v3, s[12:15], s43 offen
    buffer_load_dwordx4 v[20:23], v4, s[12:15], s42 offen
    s_add_u32 s43, s43, 1024
    s_and_b32 s43, s43, 0x7fff
    s_xor_b32 s42, s43, 1024
    s_waitcnt vmcnt(6)
    s_waitcnt lgkmcnt(6)
    v_mfma_f32_16x16x32_bf16 v[176:179], v[96:99], v[24:27], v[176:179]
    ds_read_b64_tr_b16 v[80:81], v5 offset:8192
    v_mfma_f32_16x16x32_bf16 v[192:195], v[96:99], v[28:31], v[192:195]
    ds_read_b64_tr_b16 v[82:83], v5 offset:10240
    s_waitcnt lgkmcnt(6)
    v_mfma_f32_16x16x32_bf16 v[180:183], v[100:103], v[24:27], v[180:183]
    ds_read_b64_tr_b16 v[84:85], v6 offset:8192
    v_mfma_f32_16x16x32_bf16 v[196:199], v[100:103], v[28:31], v[196:199]
    ds_read_b64_tr_b16 v[86:87], v6 offset:10240
    s_waitcnt lgkmcnt(6)
    v_mfma_f32_16x16x32_bf16 v[184:187], v[104:107], v[24:27], v[184:187]
    ds_read_b64_tr_b16 v[88:89], v7 offset:8192
    v_mfma_f32_16x16x32_bf16 v[200:203], v[104:107], v[28:31], v[200:203]
    ds_read_b64_tr_b16 v[90:91], v7 offset:10240
    s_waitcnt lgkmcnt(6)
    v_mfma_f32_16x16x32_bf16 v[188:191], v[108:111], v[24:27], v[188:191]
    ds_read_b64_tr_b16 v[92:93], v8 offset:8192
    v_mfma_f32_16x16x32_bf16 v[204:207], v[108:111], v[28:31], v[204:207]
    ds_read_b64_tr_b16 v[94:95], v8 offset:10240
    buffer_load_dwordx4 v[24:27], v3, s[12:15], s43 offen
    buffer_load_dwordx4 v[28:31], v4, s[12:15], s42 offen
    s_add_u32 s43, s43, 1024
    s_and_b32 s43, s43, 0x7fff
    s_xor_b32 s42, s43, 1024
    s_waitcnt vmcnt(6)
    s_waitcnt lgkmcnt(6)
    v_mfma_f32_16x16x32_bf16 v[176:179], v[80:83], v[32:35], v[176:179]
    ds_read_b64_tr_b16 v[96:97], v5 offset:12288
    v_mfma_f32_16x16x32_bf16 v[192:195], v[80:83], v[36:39], v[192:195]
    ds_read_b64_tr_b16 v[98:99], v5 offset:14336
    s_waitcnt lgkmcnt(6)
    v_mfma_f32_16x16x32_bf16 v[180:183], v[84:87], v[32:35], v[180:183]
    ds_read_b64_tr_b16 v[100:101], v6 offset:12288
    v_mfma_f32_16x16x32_bf16 v[196:199], v[84:87], v[36:39], v[196:199]
    ds_read_b64_tr_b16 v[102:103], v6 offset:14336
    s_waitcnt lgkmcnt(6)
    v_mfma_f32_16x16x32_bf16 v[184:187], v[88:91], v[32:35], v[184:187]
    ds_read_b64_tr_b16 v[104:105], v7 offset:12288
    v_mfma_f32_16x16x32_bf16 v[200:203], v[88:91], v[36:39], v[200:203]
    ds_read_b64_tr_b16 v[106:107], v7 offset:14336
    s_waitcnt lgkmcnt(6)
    v_mfma_f32_16x16x32_bf16 v[188:191], v[92:95], v[32:35], v[188:191]
    ds_read_b64_tr_b16 v[108:109], v8 offset:12288
    v_mfma_f32_16x16x32_bf16 v[204:207], v[92:95], v[36:39], v[204:207]
    ds_read_b64_tr_b16 v[110:111], v8 offset:14336
    buffer_load_dwordx4 v[32:35], v3, s[12:15], s43 offen
    buffer_load_dwordx4 v[36:39], v4, s[12:15], s42 offen
    s_add_u32 s43, s43, 1024
    s_and_b32 s43, s43, 0x7fff
    s_xor_b32 s42, s43, 1024
    v_add_u32 v5, 16384, v5
    v_and_b32 v5, 0x1ffff, v5
    v_add_u32 v6, 16384, v6
    v_and_b32 v6, 0x1ffff, v6
    v_add_u32 v7, 16384, v7
    v_and_b32 v7, 0x1ffff, v7
    v_add_u32 v8, 16384, v8
    v_and_b32 v8, 0x1ffff, v8
    s_waitcnt vmcnt(6)
    s_waitcnt lgkmcnt(6)
    v_mfma_f32_16x16x32_bf16 v[176:179], v[96:99], v[40:43], v[176:179]
    ds_read_b64_tr_b16 v[80:81], v5 offset:0
    v_mfma_f32_16x16x32_bf16 v[192:195], v[96:99], v[44:47], v[192:195]
    ds_read_b64_tr_b16 v[82:83], v5 offset:2048
    s_waitcnt lgkmcnt(6)
    v_mfma_f32_16x16x32_bf16 v[180:183], v[100:103], v[40:43], v[180:183]
    ds_read_b64_tr_b16 v[84:85], v6 offset:0
    v_mfma_f32_16x16x32_bf16 v[196:199], v[100:103], v[44:47], v[196:199]
    ds_read_b64_tr_b16 v[86:87], v6 offset:2048
    s_waitcnt lgkmcnt(6)
    v_mfma_f32_16x16x32_bf16 v[184:187], v[104:107], v[40:43], v[184:187]
    ds_read_b64_tr_b16 v[88:89], v7 offset:0
    v_mfma_f32_16x16x32_bf16 v[200:203], v[104:107], v[44:47], v[200:203]
    ds_read_b64_tr_b16 v[90:91], v7 offset:2048
    s_waitcnt lgkmcnt(6)
    v_mfma_f32_16x16x32_bf16 v[188:191], v[108:111], v[40:43], v[188:191]
    ds_read_b64_tr_b16 v[92:93], v8 offset:0
    v_mfma_f32_16x16x32_bf16 v[204:207], v[108:111], v[44:47], v[204:207]
    ds_read_b64_tr_b16 v[94:95], v8 offset:2048
    buffer_load_dwordx4 v[40:43], v3, s[12:15], s43 offen
    buffer_load_dwordx4 v[44:47], v4, s[12:15], s42 offen
    s_add_u32 s43, s43, 1024
    s_and_b32 s43, s43, 0x7fff
    s_xor_b32 s42, s43, 1024
    s_sub_u32 s47, s47, 1
    s_cmp_lg_u32 s47, 0
    s_cbranch_scc1 KA_gloop
    buffer_load_dwordx2 v[208:209], v9, s[8:11], 0 offen offset:0
    buffer_load_dwordx2 v[210:211], v9, s[8:11], 0 offen offset:32
    buffer_load_dwordx2 v[212:213], v9, s[8:11], 0 offen offset:64
    buffer_load_dwordx2 v[214:215], v9, s[8:11], 0 offen offset:96
    s_waitcnt vmcnt(10)
    s_waitcnt lgkmcnt(6)
    v_mfma_f32_16x16x32_bf16 v[176:179], v[80:83], v[16:19], v[176:179]
    ds_read_b64_tr_b16 v[96:97], v5 offset:4096
    v_mfma_f32_16x16x32_bf16 v[192:195], v[80:83], v[20:23], v[192:195]
    ds_read_b64_tr_b16 v[98:99], v5 offset:6144
    s_waitcnt lgkmcnt(6)
    v_mfma_f32_16x16x32_bf16 v[180:183], v[84:87], v[16:19], v[180:183]
    ds_read_b64_tr_b16 v[100:101], v6 offset:4096
    v_mfma_f32_16x16x32_bf16 v[196:199], v[84:87], v[20:23], v[196:199]
    ds_read_b64_tr_b16 v[102:103], v6 offset:6144
    s_waitcnt lgkmcnt(6)
    v_mfma_f32_16x16x32_bf16 v[184:187], v[88:91], v[16:19], v[184:187]
    ds_read_b64_tr_b16 v[104:105], v7 offset:4096
    v_mfma_f32_16x16x32_bf16 v[200:203], v[88:91], v[20:23], v[200:203]
    ds_read_b64_tr_b16 v[106:107], v7 offset:6144
    s_waitcnt lgkmcnt(6)
    v_mfma_f32_16x16x32_bf16 v[188:191], v[92:95], v[16:19], v[188:191]
    ds_read_b64_tr_b16 v[108:109], v8 offset:4096
    v_mfma_f32_16x16x32_bf16 v[204:207], v[92:95], v[20:23], v[204:207]
    ds_read_b64_tr_b16 v[110:111], v8 offset:6144
    s_waitcnt vmcnt(8)
    s_waitcnt lgkmcnt(6)
    v_mfma_f32_16x16x32_bf16 v[176:179], v[96:99], v[24:27], v[176:179]
    ds_read_b64_tr_b16 v[80:81], v5 offset:8192
    v_mfma_f32_16x16x32_bf16 v[192:195], v[96:99], v[28:31], v[192:195]
    ds_read_b64_tr_b16 v[82:83], v5 offset:10240
    s_waitcnt lgkmcnt(6)
    v_mfma_f32_16x16x32_bf16 v[180:183], v[100:103], v[24:27], v[180:183]
    ds_read_b64_tr_b16 v[84:85], v6 offset:8192
    v_mfma_f32_16x16x32_bf16 v[196:199], v[100:103], v[28:31], v[196:199]
    ds_read_b64_tr_b16 v[86:87], v6 offset:10240
    s_waitcnt lgkmcnt(6)
    v_mfma_f32_16x16x32_bf16 v[184:187], v[104:107], v[24:27], v[184:187]
    ds_read_b64_tr_b16 v[88:89], v7 offset:8192
    v_mfma_f32_16x16x32_bf16 v[200:203], v[104:107], v[28:31], v[200:203]
    ds_read_b64_tr_b16 v[90:91], v7 offset:10240
    s_waitcnt lgkmcnt(6)
    v_mfma_f32_16x16x32_bf16 v[188:191], v[108:111], v[24:27], v[188:191]
    ds_read_b64_tr_b16 v[92:93], v8 offset:8192
    v_mfma_f32_16x16x32_bf16 v[204:207], v[108:111], v[28:31], v[204:207]
    ds_read_b64_tr_b16 v[94:95], v8 offset:10240
    s_waitcnt vmcnt(6)
    s_waitcnt lgkmcnt(6)
    v_mfma_f32_16x16x32_bf16 v[176:179], v[80:83], v[32:35], v[176:179]
    ds_read_b64_tr_b16 v[96:97], v5 offset:12288
    v_mfma_f32_16x16x32_bf16 v[192:195], v[80:83], v[36:39], v[192:195]
    ds_read_b64_tr_b16 v[98:99], v5 offset:14336
    s_waitcnt lgkmcnt(6)
    v_mfma_f32_16x16x32_bf16 v[180:183], v[84:87], v[32:35], v[180:183]
    ds_read_b64_tr_b16 v[100:101], v6 offset:12288
    v_mfma_f32_16x16x32_bf16 v[196:199], v[84:87], v[36:39], v[196:199]
    ds_read_b64_tr_b16 v[102:103], v6 offset:14336
    s_waitcnt lgkmcnt(6)
    v_mfma_f32_16x16x32_bf16 v[184:187], v[88:91], v[32:35], v[184:187]
    ds_read_b64_tr_b16 v[104:105], v7 offset:12288
    v_mfma_f32_16x16x32_bf16 v[200:203], v[88:91], v[36:39], v[200:203]
    ds_read_b64_tr_b16 v[106:107], v7 offset:14336
    s_waitcnt lgkmcnt(6)
    v_mfma_f32_16x16x32_bf16 v[188:191], v[92:95], v[32:35], v[188:191]
    ds_read_b64_tr_b16 v[108:109], v8 offset:12288
    v_mfma_f32_16x16x32_bf16 v[204:207], v[92:95], v[36:39], v[204:207]
    ds_read_b64_tr_b16 v[110:111], v8 offset:14336
    s_waitcnt vmcnt(4)
    s_waitcnt lgkmcnt(6)
    v_mfma_f32_16x16x32_bf16 v[176:179], v[96:99], v[40:43], v[176:179]
    v_mfma_f32_16x16x32_bf16 v[192:195], v[96:99], v[44:47], v[192:195]
    s_waitcnt lgkmcnt(4)
    v_mfma_f32_16x16x32_bf16 v[180:183], v[100:103], v[40:43], v[180:183]
    v_mfma_f32_16x16x32_bf16 v[196:199], v[100:103], v[44:47], v[196:199]
    s_waitcnt lgkmcnt(2)
    v_mfma_f32_16x16x32_bf16 v[184:187], v[104:107], v[40:43], v[184:187]
    v_mfma_f32_16x16x32_bf16 v[200:203], v[104:107], v[44:47], v[200:203]
    s_waitcnt lgkmcnt(0)
    v_mfma_f32_16x16x32_bf16 v[188:191], v[108:111], v[40:43], v[188:191]
    v_mfma_f32_16x16x32_bf16 v[204:207], v[108:111], v[44:47], v[204:207]
    s_barrier
    s_lshl_b32 s41, s16, 12
    v_add_u32 v6, s41, v2
    s_xor_b32 s41, s41, 16384
    v_add_u32 v7, s41, v2
    s_cmp_eq_u32 s39, 0
    s_cbranch_scc0 KA_x1
    ds_write_b128 v6, v[192:195] offset:0
    ds_write_b128 v6, v[196:199] offset:1024
    ds_write_b128 v6, v[200:203] offset:2048
    ds_write_b128 v6, v[204:207] offset:3072
    s_branch KA_x2
KA_x1:
    ds_write_b128 v6, v[176:179] offset:0
    ds_write_b128 v6, v[180:183] offset:1024
    ds_write_b128 v6, v[184:187] offset:2048
    ds_write_b128 v6, v[188:191] offset:3072
    v_mov_b32 v176, v192
    v_mov_b32 v177, v193
    v_mov_b32 v178, v194
    v_mov_b32 v179, v195
    v_mov_b32 v180, v196
    v_mov_b32 v181, v197
    v_mov_b32 v182, v198
    v_mov_b32 v183, v199
    v_mov_b32 v184, v200
    v_mov_b32 v185, v201
    v_mov_b32 v186, v202
    v_mov_b32 v187, v203
    v_mov_b32 v188, v204
    v_mov_b32 v189, v205
    v_mov_b32 v190, v206
    v_mov_b32 v191, v207
KA_x2:
    s_waitcnt lgkmcnt(0)
    s_barrier
    ds_read_b128 v[32:35], v7 offset:0
    ds_read_b128 v[36:39], v7 offset:1024
    ds_read_b128 v[40:43], v7 offset:2048
    ds_read_b128 v[44:47], v7 offset:3072
    s_waitcnt lgkmcnt(0)
    v_pk_add_f32 v[176:177], v[176:177], v[32:33]
    v_pk_add_f32 v[178:179], v[178:179], v[34:35]
    v_pk_add_f32 v[180:181], v[180:181], v[36:37]
    v_pk_add_f32 v[182:183], v[182:183], v[38:39]
    v_pk_add_f32 v[184:185], v[184:185], v[40:41]
    v_pk_add_f32 v[186:187], v[186:187], v[42:43]
    v_pk_add_f32 v[188:189], v[188:189], v[44:45]
    v_pk_add_f32 v[190:191], v[190:191], v[46:47]
    s_add_u32 s40, s46, s44
    s_lshl_b32 s40, s40, 15
    s_waitcnt vmcnt(0)
    s_add_u32 s48, s34, 0x1800000
    s_addc_u32 s49, s35, 0
    s_mov_b32 s50, 0x400000
    s_mov_b32 s51, 0x20000
    s_add_u32 s52, s34, 0x1c00000
    s_addc_u32 s53, s35, 0
    s_mov_b32 s54, 0x100000
    s_mov_b32 s55, 0x20000
    v_lshlrev_b32 v16, 16, v208
    v_and_b32 v17, 0xffff0000, v208
    v_lshlrev_b32 v18, 16, v209
    v_and_b32 v19, 0xffff0000, v209
    v_lshlrev_b32 v20, 16, v210
    v_and_b32 v21, 0xffff0000, v210
    v_lshlrev_b32 v22, 16, v211
    v_and_b32 v23, 0xffff0000, v211
    v_lshlrev_b32 v24, 16, v212
    v_and_b32 v25, 0xffff0000, v212
    v_lshlrev_b32 v26, 16, v213
    v_and_b32 v27, 0xffff0000, v213
    v_lshlrev_b32 v28, 16, v214
    v_and_b32 v29, 0xffff0000, v214
    v_lshlrev_b32 v30, 16, v215
    v_and_b32 v31, 0xffff0000, v215
    v_pk_add_f32 v[176:177], v[176:177], v[16:17]
    v_pk_add_f32 v[178:179], v[178:179], v[18:19]
    v_pk_add_f32 v[180:181], v[180:181], v[20:21]
    v_pk_add_f32 v[182:183], v[182:183], v[22:23]
    v_pk_add_f32 v[184:185], v[184:185], v[24:25]
    v_pk_add_f32 v[186:187], v[186:187], v[26:27]
    v_pk_add_f32 v[188:189], v[188:189], v[28:29]
    v_pk_add_f32 v[190:191], v[190:191], v[30:31]
    s_lshl_b32 s41, s18, 11
    s_add_u32 s40, s40, s41
    v_add_u32 v14, s40, v2
    v_cvt_pk_bf16_f32 v48, v176, v177
    v_cvt_pk_bf16_f32 v49, v178, v179
    v_cvt_pk_bf16_f32 v50, v180, v181
    v_cvt_pk_bf16_f32 v51, v182, v183
    buffer_store_dwordx4 v[48:51], v14, s[48:51], 0 offen offset:0 sc1
    v_cvt_pk_bf16_f32 v52, v184, v185
    v_cvt_pk_bf16_f32 v53, v186, v187
    v_cvt_pk_bf16_f32 v54, v188, v189
    v_cvt_pk_bf16_f32 v55, v190, v191
    buffer_store_dwordx4 v[52:55], v14, s[48:51], 0 offen offset:1024 sc1
    v_pk_add_f32 v[16:17], v[176:177], v[178:179]
    v_pk_add_f32 v[18:19], v[180:181], v[182:183]
    v_pk_add_f32 v[20:21], v[184:185], v[186:187]
    v_pk_add_f32 v[22:23], v[188:189], v[190:191]
    v_pk_add_f32 v[16:17], v[16:17], v[18:19]
    v_pk_add_f32 v[20:21], v[20:21], v[22:23]
    v_pk_add_f32 v[16:17], v[16:17], v[20:21]
    v_add_f32 v16, v16, v17
    v_mov_b32 v24, v16
    s_nop 1
    v_permlane32_swap_b32 v16, v24
    v_add_f32 v16, v16, v24
    v_mov_b32 v24, v16
    s_nop 1
    v_permlane16_swap_b32 v16, v24
    v_add_f32 v16, v16, v24
    v_mul_f32 v16, 0x3c800000, v16
    v_pk_add_f32 v[176:177], v[176:177], v[16:17] op_sel_hi:[1,0] neg_lo:[0,1] neg_hi:[0,1]
    v_pk_add_f32 v[178:179], v[178:179], v[16:17] op_sel_hi:[1,0] neg_lo:[0,1] neg_hi:[0,1]
    v_pk_add_f32 v[180:181], v[180:181], v[16:17] op_sel_hi:[1,0] neg_lo:[0,1] neg_hi:[0,1]
    v_pk_add_f32 v[182:183], v[182:183], v[16:17] op_sel_hi:[1,0] neg_lo:[0,1] neg_hi:[0,1]
    v_pk_add_f32 v[184:185], v[184:185], v[16:17] op_sel_hi:[1,0] neg_lo:[0,1] neg_hi:[0,1]
    v_pk_add_f32 v[186:187], v[186:187], v[16:17] op_sel_hi:[1,0] neg_lo:[0,1] neg_hi:[0,1]
    v_pk_add_f32 v[188:189], v[188:189], v[16:17] op_sel_hi:[1,0] neg_lo:[0,1] neg_hi:[0,1]
    v_pk_add_f32 v[190:191], v[190:191], v[16:17] op_sel_hi:[1,0] neg_lo:[0,1] neg_hi:[0,1]
    v_pk_mul_f32 v[20:21], v[176:177], v[176:177]
    v_pk_mul_f32 v[22:23], v[178:179], v[178:179]
    v_pk_fma_f32 v[20:21], v[180:181], v[180:181], v[20:21]
    v_pk_fma_f32 v[22:23], v[182:183], v[182:183], v[22:23]
    v_pk_fma_f32 v[20:21], v[184:185], v[184:185], v[20:21]
    v_pk_fma_f32 v[22:23], v[186:187], v[186:187], v[22:23]
    v_pk_fma_f32 v[20:21], v[188:189], v[188:189], v[20:21]
    v_pk_fma_f32 v[22:23], v[190:191], v[190:191], v[22:23]
    v_pk_add_f32 v[20:21], v[20:21], v[22:23]
    v_add_f32 v17, v20, v21
    v_mov_b32 v24, v17
    s_nop 1
    v_permlane32_swap_b32 v17, v24
    v_add_f32 v17, v17, v24
    v_mov_b32 v24, v17
    s_nop 1
    v_permlane16_swap_b32 v17, v24
    v_add_f32 v17, v17, v24
    v_lshlrev_b32 v13, 7, v241
    s_lshl_b32 s41, s18, 3
    v_add_u32 v13, s41, v13
    v_cmp_gt_u32 vcc, 16, v1
    s_nop 3
    s_and_saveexec_b64 s[56:57], vcc
    buffer_store_dwordx2 v[16:17], v13, s[52:55], 0 offen sc1
    s_mov_b64 exec, s[56:57]
    s_waitcnt vmcnt(0)
    s_barrier
    s_cmp_lg_u32 s16, 0
    s_cbranch_scc1 KA_nosig
    s_add_u32 s56, s34, 0x1e00000
    s_addc_u32 s57, s35, 0
    s_mov_b32 s58, 0x10000
    s_mov_b32 s59, 0x20000
    s_add_u32 s41, s30, 80
    s_lshl_b32 s41, s41, 8
    v_mov_b32 v40, 1
    v_mov_b32 v41, 0
    s_mov_b64 s[78:79], exec
    s_mov_b64 exec, 1
    buffer_atomic_add v40, v41, s[56:59], s41 offen
    s_mov_b64 exec, s[78:79]
KA_nosig:
    s_load_dwordx2 s[34:35], s[0:1], 88
    s_load_dwordx2 s[32:33], s[0:1], 40
    s_load_dwordx2 s[36:37], s[0:1], 48
    s_and_b32 s40, s2, 7
    s_lshr_b32 s41, s2, 3
    s_lshr_b32 s66, s41, 3
    s_and_b32 s67, s41, 7
    s_and_b32 s42, s40, 1
    s_lshl_b32 s42, s42, 3
    s_and_b32 s43, s41, 7
    s_add_u32 s17, s42, s43
    s_lshr_b32 s42, s40, 1
    s_lshl_b32 s42, s42, 2
    s_lshr_b32 s43, s41, 3
    s_add_u32 s18, s42, s43
    s_lshl_b32 s44, s17, 3
    s_and_b32 s43, s18, 1
    s_mul_i32 s45, s18, 448
    s_lshl_b32 s42, s43, 6
    s_sub_u32 s45, s45, s42
    s_add_u32 s46, s45, 128
    s_add_u32 s47, s45, 256
    s_add_u32 s48, s45, 384
    s_waitcnt lgkmcnt(0)
    s_add_u32 s4, s34, 0x1800000
    s_addc_u32 s5, s35, 0
    s_mov_b32 s6, 0x400000
    s_mov_b32 s7, 0x20000
    s_mov_b32 s8, s32
    s_mov_b32 s9, s33
    s_mov_b32 s10, 0x700000
    s_mov_b32 s11, 0x20000
    s_cmp_ge_u32 s16, 4
    s_cbranch_scc1 K3_loader
    s_lshr_b32 s38, s16, 1
    s_and_b32 s39, s16, 1
    s_mul_i32 s25, s38, 8192
    v_lshlrev_b32 v2, 4, v1
    v_add_u32 v2, s25, v2
    v_bfe_u32 v9, v1, 1, 1
    v_bfe_u32 v10, v1, 3, 2
    v_lshlrev_b32 v10, 1, v10
    v_xor_b32 v9, v9, v10
    v_lshrrev_b32 v10, 2, v1
    v_lshlrev_b32 v3, 7, v10
    v_lshl_add_u32 v3, v9, 4, v3
    v_and_b32 v10, 1, v1
    v_lshl_add_u32 v3, v10, 3, v3
    s_mul_i32 s40, s39, 7
    s_lshl_b32 s41, s43, 1
    s_add_u32 s40, s40, s41
    v_mov_b32 v9, v3
    s_add_u32 s41, s40, 0
    s_and_b32 s42, s41, 3
    s_lshl_b32 s42, s42, 5
    v_xor_b32 v3, s42, v9
    s_lshr_b32 s42, s41, 2
    s_lshl_b32 s42, s42, 13
    v_add_u32 v3, s42, v3
    s_add_u32 s41, s40, 1
    s_and_b32 s42, s41, 3
    s_lshl_b32 s42, s42, 5
    v_xor_b32 v4, s42, v9
    s_lshr_b32 s42, s41, 2
    s_lshl_b32 s42, s42, 13
    v_add_u32 v4, s42, v4
    s_add_u32 s41, s40, 2
    s_and_b32 s42, s41, 3
    s_lshl_b32 s42, s42, 5
    v_xor_b32 v5, s42, v9
    s_lshr_b32 s42, s41, 2
    s_lshl_b32 s42, s42, 13
    v_add_u32 v5, s42, v5
    s_add_u32 s41, s40, 3
    s_and_b32 s42, s41, 3
    s_lshl_b32 s42, s42, 5
    v_xor_b32 v6, s42, v9
    s_lshr_b32 s42, s41, 2
    s_lshl_b32 s42, s42, 13
    v_add_u32 v6, s42, v6
    s_add_u32 s48, s34, 0x2000000
    s_addc_u32 s49, s35, 0
    s_mov_b32 s50, 0xe00000
    s_mov_b32 s51, 0x20000
    s_mov_b32 s56, s36
    s_mov_b32 s57, s37
    s_mov_b32 s58, 0x1c00
    s_mov_b32 s59, 0x20000
    s_mul_i32 s40, s18, 224
    s_mul_i32 s41, s39, 112
    s_add_u32 s40, s40, s41
    v_lshrrev_b32 v9, 4, v1
    v_lshlrev_b32 v9, 2, v9
    v_add_u32 v9, s40, v9
    v_lshlrev_b32 v10, 2, v9
    v_lshlrev_b32 v11, 1, v9
    s_lshl_b32 s40, s38, 2
    s_add_u32 s40, s40, s44
    s_mul_i32 s40, s40, 112
    s_mul_i32 s41, s18, 7
    s_add_u32 s40, s40, s41
    s_mul_i32 s41, s39, 3
    s_add_u32 s40, s40, s41
    s_lshl_b32 s40, s40, 10
    v_lshlrev_b32 v14, 4, v1
    v_add_u32 v14, s40, v14
    s_mov_b32 s26, 0
    s_mov_b32 s27, 0xfffe8000
    s_mov_b32 s28, 49152
    s_mov_b32 s19, 14
    s_barrier
    ds_read_b128 v[16:19], v2 offset:0
    ds_read_b64_tr_b16 v[32:33], v3 offset:16384
    ds_read_b64_tr_b16 v[34:35], v3 offset:18432
    ds_read_b128 v[20:23], v2 offset:2048
    ds_read_b128 v[24:27], v2 offset:4096
    ds_read_b128 v[28:31], v2 offset:6144
    ds_read_b64_tr_b16 v[36:37], v4 offset:16384
    ds_read_b64_tr_b16 v[38:39], v4 offset:18432
    ds_read_b64_tr_b16 v[40:41], v5 offset:16384
    ds_read_b64_tr_b16 v[42:43], v5 offset:18432
    ds_read_b64_tr_b16 v[44:45], v6 offset:16384
    ds_read_b64_tr_b16 v[46:47], v6 offset:18432
    ds_read_b64_tr_b16 v[48:49], v3 offset:24576
    ds_read_b64_tr_b16 v[50:51], v3 offset:26624
    ds_read_b64_tr_b16 v[52:53], v4 offset:24576
    ds_read_b64_tr_b16 v[54:55], v4 offset:26624
    ds_read_b64_tr_b16 v[56:57], v5 offset:24576
    ds_read_b64_tr_b16 v[58:59], v5 offset:26624
    buffer_load_dwordx2 v[224:225], v11, s[56:59], 0 offen offset:0
    buffer_load_dwordx2 v[226:227], v11, s[56:59], 0 offen offset:32
    buffer_load_dwordx2 v[228:229], v11, s[56:59], 0 offen offset:64
    buffer_load_dwordx2 v[230:231], v11, s[56:59], 0 offen offset:96
    buffer_load_dwordx2 v[232:233], v11, s[56:59], 0 offen offset:128
    buffer_load_dwordx2 v[234:235], v11, s[56:59], 0 offen offset:160
    buffer_load_dwordx2 v[236:237], v11, s[56:59], 0 offen offset:192
    s_waitcnt lgkmcnt(15)
    v_mfma_f32_16x16x32_bf16 v[112:115], v[32:35], v[16:19], 0
    ds_read_b128 v[60:63], v2 offset:1024
    s_waitcnt lgkmcnt(15)
    v_mfma_f32_16x16x32_bf16 v[140:143], v[32:35], v[20:23], 0
    ds_read_b64_tr_b16 v[76:77], v3 offset:20480
    s_waitcnt lgkmcnt(15)
    v_mfma_f32_16x16x32_bf16 v[168:171], v[32:35], v[24:27], 0
    ds_read_b64_tr_b16 v[78:79], v3 offset:22528
    s_waitcnt lgkmcnt(15)
    v_mfma_f32_16x16x32_bf16 v[196:199], v[32:35], v[28:31], 0
    ds_read_b128 v[64:67], v2 offset:3072
    s_waitcnt lgkmcnt(14)
    v_mfma_f32_16x16x32_bf16 v[116:119], v[36:39], v[16:19], 0
    ds_read_b128 v[68:71], v2 offset:5120
    v_mfma_f32_16x16x32_bf16 v[144:147], v[36:39], v[20:23], 0
    ds_read_b128 v[72:75], v2 offset:7168
    v_mfma_f32_16x16x32_bf16 v[172:175], v[36:39], v[24:27], 0
    ds_read_b64_tr_b16 v[80:81], v4 offset:20480
    v_mfma_f32_16x16x32_bf16 v[200:203], v[36:39], v[28:31], 0
    ds_read_b64_tr_b16 v[82:83], v4 offset:22528
    s_waitcnt lgkmcnt(15)
    v_mfma_f32_16x16x32_bf16 v[120:123], v[40:43], v[16:19], 0
    ds_read_b64_tr_b16 v[84:85], v5 offset:20480
    v_mfma_f32_16x16x32_bf16 v[148:151], v[40:43], v[20:23], 0
    ds_read_b64_tr_b16 v[86:87], v5 offset:22528
    v_mfma_f32_16x16x32_bf16 v[176:179], v[40:43], v[24:27], 0
    ds_read_b64_tr_b16 v[88:89], v6 offset:20480
    v_mfma_f32_16x16x32_bf16 v[204:207], v[40:43], v[28:31], 0
    ds_read_b64_tr_b16 v[90:91], v6 offset:22528
    s_waitcnt lgkmcnt(15)
    v_mfma_f32_16x16x32_bf16 v[124:127], v[44:47], v[16:19], 0
    ds_read_b64_tr_b16 v[92:93], v3 offset:28672
    v_mfma_f32_16x16x32_bf16 v[152:155], v[44:47], v[20:23], 0
    ds_read_b64_tr_b16 v[94:95], v3 offset:30720
    v_mfma_f32_16x16x32_bf16 v[180:183], v[44:47], v[24:27], 0
    ds_read_b64_tr_b16 v[96:97], v4 offset:28672
    v_mfma_f32_16x16x32_bf16 v[208:211], v[44:47], v[28:31], 0
    ds_read_b64_tr_b16 v[98:99], v4 offset:30720
    v_mfma_f32_16x16x32_bf16 v[128:131], v[48:51], v[16:19], 0
    ds_read_b64_tr_b16 v[100:101], v5 offset:28672
    v_mfma_f32_16x16x32_bf16 v[156:159], v[48:51], v[20:23], 0
    ds_read_b64_tr_b16 v[102:103], v5 offset:30720
    s_add_u32 s26, s26, 49152
    s_cmp_eq_u32 s26, 147456
    s_cselect_b32 s23, s27, s28
    s_cselect_b32 s26, 0, s26
    v_add_u32 v2, s23, v2
    v_add_u32 v3, s23, v3
    v_add_u32 v4, s23, v4
    v_add_u32 v5, s23, v5
    v_add_u32 v6, s23, v6
    v_mfma_f32_16x16x32_bf16 v[184:187], v[48:51], v[24:27], 0
    v_mfma_f32_16x16x32_bf16 v[212:215], v[48:51], v[28:31], 0
    s_waitcnt lgkmcnt(15)
    v_mfma_f32_16x16x32_bf16 v[132:135], v[52:55], v[16:19], 0
    v_mfma_f32_16x16x32_bf16 v[160:163], v[52:55], v[20:23], 0
    v_mfma_f32_16x16x32_bf16 v[188:191], v[52:55], v[24:27], 0
    v_mfma_f32_16x16x32_bf16 v[216:219], v[52:55], v[28:31], 0
    v_mfma_f32_16x16x32_bf16 v[136:139], v[56:59], v[16:19], 0
    v_mfma_f32_16x16x32_bf16 v[164:167], v[56:59], v[20:23], 0
    v_mfma_f32_16x16x32_bf16 v[192:195], v[56:59], v[24:27], 0
    v_mfma_f32_16x16x32_bf16 v[220:223], v[56:59], v[28:31], 0
    s_waitcnt lgkmcnt(0)
    s_barrier
    v_mfma_f32_16x16x32_bf16 v[112:115], v[76:79], v[60:63], v[112:115]
    ds_read_b128 v[16:19], v2 offset:0
    v_mfma_f32_16x16x32_bf16 v[140:143], v[76:79], v[64:67], v[140:143]
    ds_read_b64_tr_b16 v[32:33], v3 offset:16384
    v_mfma_f32_16x16x32_bf16 v[168:171], v[76:79], v[68:71], v[168:171]
    ds_read_b64_tr_b16 v[34:35], v3 offset:18432
    v_mfma_f32_16x16x32_bf16 v[196:199], v[76:79], v[72:75], v[196:199]
    ds_read_b128 v[20:23], v2 offset:2048
    v_mfma_f32_16x16x32_bf16 v[116:119], v[80:83], v[60:63], v[116:119]
    ds_read_b128 v[24:27], v2 offset:4096
    v_mfma_f32_16x16x32_bf16 v[144:147], v[80:83], v[64:67], v[144:147]
    ds_read_b128 v[28:31], v2 offset:6144
    v_mfma_f32_16x16x32_bf16 v[172:175], v[80:83], v[68:71], v[172:175]
    ds_read_b64_tr_b16 v[36:37], v4 offset:16384
    v_mfma_f32_16x16x32_bf16 v[200:203], v[80:83], v[72:75], v[200:203]
    ds_read_b64_tr_b16 v[38:39], v4 offset:18432
    v_mfma_f32_16x16x32_bf16 v[120:123], v[84:87], v[60:63], v[120:123]
    ds_read_b64_tr_b16 v[40:41], v5 offset:16384
    v_mfma_f32_16x16x32_bf16 v[148:151], v[84:87], v[64:67], v[148:151]
    ds_read_b64_tr_b16 v[42:43], v5 offset:18432
    v_mfma_f32_16x16x32_bf16 v[176:179], v[84:87], v[68:71], v[176:179]
    ds_read_b64_tr_b16 v[44:45], v6 offset:16384
    v_mfma_f32_16x16x32_bf16 v[204:207], v[84:87], v[72:75], v[204:207]
    ds_read_b64_tr_b16 v[46:47], v6 offset:18432
    v_mfma_f32_16x16x32_bf16 v[124:127], v[88:91], v[60:63], v[124:127]
    ds_read_b64_tr_b16 v[48:49], v3 offset:24576
    v_mfma_f32_16x16x32_bf16 v[152:155], v[88:91], v[64:67], v[152:155]
    ds_read_b64_tr_b16 v[50:51], v3 offset:26624
    v_mfma_f32_16x16x32_bf16 v[180:183], v[88:91], v[68:71], v[180:183]
    ds_read_b64_tr_b16 v[52:53], v4 offset:24576
    v_mfma_f32_16x16x32_bf16 v[208:211], v[88:91], v[72:75], v[208:211]
    ds_read_b64_tr_b16 v[54:55], v4 offset:26624
    v_mfma_f32_16x16x32_bf16 v[128:131], v[92:95], v[60:63], v[128:131]
    ds_read_b64_tr_b16 v[56:57], v5 offset:24576
    v_mfma_f32_16x16x32_bf16 v[156:159], v[92:95], v[64:67], v[156:159]
    ds_read_b64_tr_b16 v[58:59], v5 offset:26624
    v_mfma_f32_16x16x32_bf16 v[184:187], v[92:95], v[68:71], v[184:187]
    v_mfma_f32_16x16x32_bf16 v[212:215], v[92:95], v[72:75], v[212:215]
    v_mfma_f32_16x16x32_bf16 v[132:135], v[96:99], v[60:63], v[132:135]
    v_mfma_f32_16x16x32_bf16 v[160:163], v[96:99], v[64:67], v[160:163]
    v_mfma_f32_16x16x32_bf16 v[188:191], v[96:99], v[68:71], v[188:191]
    v_mfma_f32_16x16x32_bf16 v[216:219], v[96:99], v[72:75], v[216:219]
    v_mfma_f32_16x16x32_bf16 v[136:139], v[100:103], v[60:63], v[136:139]
    v_mfma_f32_16x16x32_bf16 v[164:167], v[100:103], v[64:67], v[164:167]
    v_mfma_f32_16x16x32_bf16 v[192:195], v[100:103], v[68:71], v[192:195]
    v_mfma_f32_16x16x32_bf16 v[220:223], v[100:103], v[72:75], v[220:223]
K3_cloop:
    s_waitcnt lgkmcnt(15)
    v_mfma_f32_16x16x32_bf16 v[112:115], v[32:35], v[16:19], v[112:115]
    ds_read_b128 v[60:63], v2 offset:1024
    s_waitcnt lgkmcnt(15)
    v_mfma_f32_16x16x32_bf16 v[140:143], v[32:35], v[20:23], v[140:143]
    ds_read_b64_tr_b16 v[76:77], v3 offset:20480
    s_waitcnt lgkmcnt(15)
    v_mfma_f32_16x16x32_bf16 v[168:171], v[32:35], v[24:27], v[168:171]
    ds_read_b64_tr_b16 v[78:79], v3 offset:22528
    s_waitcnt lgkmcnt(15)
    v_mfma_f32_16x16x32_bf16 v[196:199], v[32:35], v[28:31], v[196:199]
    ds_read_b128 v[64:67], v2 offset:3072
    s_waitcnt lgkmcnt(14)
    v_mfma_f32_16x16x32_bf16 v[116:119], v[36:39], v[16:19], v[116:119]
    ds_read_b128 v[68:71], v2 offset:5120
    v_mfma_f32_16x16x32_bf16 v[144:147], v[36:39], v[20:23], v[144:147]
    ds_read_b128 v[72:75], v2 offset:7168
    v_mfma_f32_16x16x32_bf16 v[172:175], v[36:39], v[24:27], v[172:175]
    ds_read_b64_tr_b16 v[80:81], v4 offset:20480
    v_mfma_f32_16x16x32_bf16 v[200:203], v[36:39], v[28:31], v[200:203]
    ds_read_b64_tr_b16 v[82:83], v4 offset:22528
    s_waitcnt lgkmcnt(15)
    v_mfma_f32_16x16x32_bf16 v[120:123], v[40:43], v[16:19], v[120:123]
    ds_read_b64_tr_b16 v[84:85], v5 offset:20480
    v_mfma_f32_16x16x32_bf16 v[148:151], v[40:43], v[20:23], v[148:151]
    ds_read_b64_tr_b16 v[86:87], v5 offset:22528
    v_mfma_f32_16x16x32_bf16 v[176:179], v[40:43], v[24:27], v[176:179]
    ds_read_b64_tr_b16 v[88:89], v6 offset:20480
    v_mfma_f32_16x16x32_bf16 v[204:207], v[40:43], v[28:31], v[204:207]
    ds_read_b64_tr_b16 v[90:91], v6 offset:22528
    s_waitcnt lgkmcnt(15)
    v_mfma_f32_16x16x32_bf16 v[124:127], v[44:47], v[16:19], v[124:127]
    ds_read_b64_tr_b16 v[92:93], v3 offset:28672
    v_mfma_f32_16x16x32_bf16 v[152:155], v[44:47], v[20:23], v[152:155]
    ds_read_b64_tr_b16 v[94:95], v3 offset:30720
    v_mfma_f32_16x16x32_bf16 v[180:183], v[44:47], v[24:27], v[180:183]
    ds_read_b64_tr_b16 v[96:97], v4 offset:28672
    v_mfma_f32_16x16x32_bf16 v[208:211], v[44:47], v[28:31], v[208:211]
    ds_read_b64_tr_b16 v[98:99], v4 offset:30720
    v_mfma_f32_16x16x32_bf16 v[128:131], v[48:51], v[16:19], v[128:131]
    ds_read_b64_tr_b16 v[100:101], v5 offset:28672
    v_mfma_f32_16x16x32_bf16 v[156:159], v[48:51], v[20:23], v[156:159]
    ds_read_b64_tr_b16 v[102:103], v5 offset:30720
    s_add_u32 s26, s26, 49152
    s_cmp_eq_u32 s26, 147456
    s_cselect_b32 s23, s27, s28
    s_cselect_b32 s26, 0, s26
    v_add_u32 v2, s23, v2
    v_add_u32 v3, s23, v3
    v_add_u32 v4, s23, v4
    v_add_u32 v5, s23, v5
    v_add_u32 v6, s23, v6
    v_mfma_f32_16x16x32_bf16 v[184:187], v[48:51], v[24:27], v[184:187]
    v_mfma_f32_16x16x32_bf16 v[212:215], v[48:51], v[28:31], v[212:215]
    s_waitcnt lgkmcnt(15)
    v_mfma_f32_16x16x32_bf16 v[132:135], v[52:55], v[16:19], v[132:135]
    v_mfma_f32_16x16x32_bf16 v[160:163], v[52:55], v[20:23], v[160:163]
    v_mfma_f32_16x16x32_bf16 v[188:191], v[52:55], v[24:27], v[188:191]
    v_mfma_f32_16x16x32_bf16 v[216:219], v[52:55], v[28:31], v[216:219]
    v_mfma_f32_16x16x32_bf16 v[136:139], v[56:59], v[16:19], v[136:139]
    v_mfma_f32_16x16x32_bf16 v[164:167], v[56:59], v[20:23], v[164:167]
    v_mfma_f32_16x16x32_bf16 v[192:195], v[56:59], v[24:27], v[192:195]
    v_mfma_f32_16x16x32_bf16 v[220:223], v[56:59], v[28:31], v[220:223]
    s_sub_u32 s19, s19, 1
    s_waitcnt lgkmcnt(0)
    s_barrier
    v_mfma_f32_16x16x32_bf16 v[112:115], v[76:79], v[60:63], v[112:115]
    ds_read_b128 v[16:19], v2 offset:0
    v_mfma_f32_16x16x32_bf16 v[140:143], v[76:79], v[64:67], v[140:143]
    ds_read_b64_tr_b16 v[32:33], v3 offset:16384
    v_mfma_f32_16x16x32_bf16 v[168:171], v[76:79], v[68:71], v[168:171]
    ds_read_b64_tr_b16 v[34:35], v3 offset:18432
    v_mfma_f32_16x16x32_bf16 v[196:199], v[76:79], v[72:75], v[196:199]
    ds_read_b128 v[20:23], v2 offset:2048
    v_mfma_f32_16x16x32_bf16 v[116:119], v[80:83], v[60:63], v[116:119]
    ds_read_b128 v[24:27], v2 offset:4096
    v_mfma_f32_16x16x32_bf16 v[144:147], v[80:83], v[64:67], v[144:147]
    ds_read_b128 v[28:31], v2 offset:6144
    v_mfma_f32_16x16x32_bf16 v[172:175], v[80:83], v[68:71], v[172:175]
    ds_read_b64_tr_b16 v[36:37], v4 offset:16384
    v_mfma_f32_16x16x32_bf16 v[200:203], v[80:83], v[72:75], v[200:203]
    ds_read_b64_tr_b16 v[38:39], v4 offset:18432
    v_mfma_f32_16x16x32_bf16 v[120:123], v[84:87], v[60:63], v[120:123]
    ds_read_b64_tr_b16 v[40:41], v5 offset:16384
    v_mfma_f32_16x16x32_bf16 v[148:151], v[84:87], v[64:67], v[148:151]
    ds_read_b64_tr_b16 v[42:43], v5 offset:18432
    v_mfma_f32_16x16x32_bf16 v[176:179], v[84:87], v[68:71], v[176:179]
    ds_read_b64_tr_b16 v[44:45], v6 offset:16384
    v_mfma_f32_16x16x32_bf16 v[204:207], v[84:87], v[72:75], v[204:207]
    ds_read_b64_tr_b16 v[46:47], v6 offset:18432
    v_mfma_f32_16x16x32_bf16 v[124:127], v[88:91], v[60:63], v[124:127]
    ds_read_b64_tr_b16 v[48:49], v3 offset:24576
    v_mfma_f32_16x16x32_bf16 v[152:155], v[88:91], v[64:67], v[152:155]
    ds_read_b64_tr_b16 v[50:51], v3 offset:26624
    v_mfma_f32_16x16x32_bf16 v[180:183], v[88:91], v[68:71], v[180:183]
    ds_read_b64_tr_b16 v[52:53], v4 offset:24576
    v_mfma_f32_16x16x32_bf16 v[208:211], v[88:91], v[72:75], v[208:211]
    ds_read_b64_tr_b16 v[54:55], v4 offset:26624
    v_mfma_f32_16x16x32_bf16 v[128:131], v[92:95], v[60:63], v[128:131]
    ds_read_b64_tr_b16 v[56:57], v5 offset:24576
    v_mfma_f32_16x16x32_bf16 v[156:159], v[92:95], v[64:67], v[156:159]
    ds_read_b64_tr_b16 v[58:59], v5 offset:26624
    v_mfma_f32_16x16x32_bf16 v[184:187], v[92:95], v[68:71], v[184:187]
    v_mfma_f32_16x16x32_bf16 v[212:215], v[92:95], v[72:75], v[212:215]
    v_mfma_f32_16x16x32_bf16 v[132:135], v[96:99], v[60:63], v[132:135]
    v_mfma_f32_16x16x32_bf16 v[160:163], v[96:99], v[64:67], v[160:163]
    v_mfma_f32_16x16x32_bf16 v[188:191], v[96:99], v[68:71], v[188:191]
    v_mfma_f32_16x16x32_bf16 v[216:219], v[96:99], v[72:75], v[216:219]
    v_mfma_f32_16x16x32_bf16 v[136:139], v[100:103], v[60:63], v[136:139]
    v_mfma_f32_16x16x32_bf16 v[164:167], v[100:103], v[64:67], v[164:167]
    v_mfma_f32_16x16x32_bf16 v[192:195], v[100:103], v[68:71], v[192:195]
    v_mfma_f32_16x16x32_bf16 v[220:223], v[100:103], v[72:75], v[220:223]
    s_cmp_lg_u32 s19, 0
    s_cbranch_scc1 K3_cloop
    s_waitcnt lgkmcnt(15)
    v_mfma_f32_16x16x32_bf16 v[112:115], v[32:35], v[16:19], v[112:115]
    ds_read_b128 v[60:63], v2 offset:1024
    s_waitcnt lgkmcnt(15)
    v_mfma_f32_16x16x32_bf16 v[140:143], v[32:35], v[20:23], v[140:143]
    ds_read_b64_tr_b16 v[76:77], v3 offset:20480
    s_waitcnt lgkmcnt(15)
    v_mfma_f32_16x16x32_bf16 v[168:171], v[32:35], v[24:27], v[168:171]
    ds_read_b64_tr_b16 v[78:79], v3 offset:22528
    s_waitcnt lgkmcnt(15)
    v_mfma_f32_16x16x32_bf16 v[196:199], v[32:35], v[28:31], v[196:199]
    ds_read_b128 v[64:67], v2 offset:3072
    s_waitcnt lgkmcnt(14)
    v_mfma_f32_16x16x32_bf16 v[116:119], v[36:39], v[16:19], v[116:119]
    ds_read_b128 v[68:71], v2 offset:5120
    v_mfma_f32_16x16x32_bf16 v[144:147], v[36:39], v[20:23], v[144:147]
    ds_read_b128 v[72:75], v2 offset:7168
    v_mfma_f32_16x16x32_bf16 v[172:175], v[36:39], v[24:27], v[172:175]
    ds_read_b64_tr_b16 v[80:81], v4 offset:20480
    v_mfma_f32_16x16x32_bf16 v[200:203], v[36:39], v[28:31], v[200:203]
    ds_read_b64_tr_b16 v[82:83], v4 offset:22528
    s_waitcnt lgkmcnt(15)
    v_mfma_f32_16x16x32_bf16 v[120:123], v[40:43], v[16:19], v[120:123]
    ds_read_b64_tr_b16 v[84:85], v5 offset:20480
    v_mfma_f32_16x16x32_bf16 v[148:151], v[40:43], v[20:23], v[148:151]
    ds_read_b64_tr_b16 v[86:87], v5 offset:22528
    v_mfma_f32_16x16x32_bf16 v[176:179], v[40:43], v[24:27], v[176:179]
    ds_read_b64_tr_b16 v[88:89], v6 offset:20480
    v_mfma_f32_16x16x32_bf16 v[204:207], v[40:43], v[28:31], v[204:207]
    ds_read_b64_tr_b16 v[90:91], v6 offset:22528
    s_waitcnt lgkmcnt(15)
    v_mfma_f32_16x16x32_bf16 v[124:127], v[44:47], v[16:19], v[124:127]
    ds_read_b64_tr_b16 v[92:93], v3 offset:28672
    v_mfma_f32_16x16x32_bf16 v[152:155], v[44:47], v[20:23], v[152:155]
    ds_read_b64_tr_b16 v[94:95], v3 offset:30720
    v_mfma_f32_16x16x32_bf16 v[180:183], v[44:47], v[24:27], v[180:183]
    ds_read_b64_tr_b16 v[96:97], v4 offset:28672
    v_mfma_f32_16x16x32_bf16 v[208:211], v[44:47], v[28:31], v[208:211]
    ds_read_b64_tr_b16 v[98:99], v4 offset:30720
    v_mfma_f32_16x16x32_bf16 v[128:131], v[48:51], v[16:19], v[128:131]
    ds_read_b64_tr_b16 v[100:101], v5 offset:28672
    v_mfma_f32_16x16x32_bf16 v[156:159], v[48:51], v[20:23], v[156:159]
    ds_read_b64_tr_b16 v[102:103], v5 offset:30720
    v_mfma_f32_16x16x32_bf16 v[184:187], v[48:51], v[24:27], v[184:187]
    v_mfma_f32_16x16x32_bf16 v[212:215], v[48:51], v[28:31], v[212:215]
    s_waitcnt lgkmcnt(15)
    v_mfma_f32_16x16x32_bf16 v[132:135], v[52:55], v[16:19], v[132:135]
    v_mfma_f32_16x16x32_bf16 v[160:163], v[52:55], v[20:23], v[160:163]
    v_mfma_f32_16x16x32_bf16 v[188:191], v[52:55], v[24:27], v[188:191]
    v_mfma_f32_16x16x32_bf16 v[216:219], v[52:55], v[28:31], v[216:219]
    v_mfma_f32_16x16x32_bf16 v[136:139], v[56:59], v[16:19], v[136:139]
    v_mfma_f32_16x16x32_bf16 v[164:167], v[56:59], v[20:23], v[164:167]
    v_mfma_f32_16x16x32_bf16 v[192:195], v[56:59], v[24:27], v[192:195]
    v_mfma_f32_16x16x32_bf16 v[220:223], v[56:59], v[28:31], v[220:223]
    v_mfma_f32_16x16x32_bf16 v[112:115], v[76:79], v[60:63], v[112:115]
    s_waitcnt lgkmcnt(14)
    v_mfma_f32_16x16x32_bf16 v[140:143], v[76:79], v[64:67], v[140:143]
    s_waitcnt lgkmcnt(13)
    v_mfma_f32_16x16x32_bf16 v[168:171], v[76:79], v[68:71], v[168:171]
    s_waitcnt lgkmcnt(12)
    v_mfma_f32_16x16x32_bf16 v[196:199], v[76:79], v[72:75], v[196:199]
    s_waitcnt lgkmcnt(10)
    v_mfma_f32_16x16x32_bf16 v[116:119], v[80:83], v[60:63], v[116:119]
    v_mfma_f32_16x16x32_bf16 v[144:147], v[80:83], v[64:67], v[144:147]
    v_mfma_f32_16x16x32_bf16 v[172:175], v[80:83], v[68:71], v[172:175]
    v_mfma_f32_16x16x32_bf16 v[200:203], v[80:83], v[72:75], v[200:203]
    s_waitcnt lgkmcnt(8)
    v_mfma_f32_16x16x32_bf16 v[120:123], v[84:87], v[60:63], v[120:123]
    v_mfma_f32_16x16x32_bf16 v[148:151], v[84:87], v[64:67], v[148:151]
    v_mfma_f32_16x16x32_bf16 v[176:179], v[84:87], v[68:71], v[176:179]
    v_mfma_f32_16x16x32_bf16 v[204:207], v[84:87], v[72:75], v[204:207]
    s_waitcnt lgkmcnt(6)
    v_mfma_f32_16x16x32_bf16 v[124:127], v[88:91], v[60:63], v[124:127]
    v_mfma_f32_16x16x32_bf16 v[152:155], v[88:91], v[64:67], v[152:155]
    v_mfma_f32_16x16x32_bf16 v[180:183], v[88:91], v[68:71], v[180:183]
    v_mfma_f32_16x16x32_bf16 v[208:211], v[88:91], v[72:75], v[208:211]
    s_waitcnt lgkmcnt(4)
    v_mfma_f32_16x16x32_bf16 v[128:131], v[92:95], v[60:63], v[128:131]
    v_mfma_f32_16x16x32_bf16 v[156:159], v[92:95], v[64:67], v[156:159]
    v_mfma_f32_16x16x32_bf16 v[184:187], v[92:95], v[68:71], v[184:187]
    v_mfma_f32_16x16x32_bf16 v[212:215], v[92:95], v[72:75], v[212:215]
    s_waitcnt lgkmcnt(2)
    v_mfma_f32_16x16x32_bf16 v[132:135], v[96:99], v[60:63], v[132:135]
    v_mfma_f32_16x16x32_bf16 v[160:163], v[96:99], v[64:67], v[160:163]
    v_mfma_f32_16x16x32_bf16 v[188:191], v[96:99], v[68:71], v[188:191]
    v_mfma_f32_16x16x32_bf16 v[216:219], v[96:99], v[72:75], v[216:219]
    s_waitcnt lgkmcnt(0)
    v_mfma_f32_16x16x32_bf16 v[136:139], v[100:103], v[60:63], v[136:139]
    v_mfma_f32_16x16x32_bf16 v[164:167], v[100:103], v[64:67], v[164:167]
    v_mfma_f32_16x16x32_bf16 v[192:195], v[100:103], v[68:71], v[192:195]
    v_mfma_f32_16x16x32_bf16 v[220:223], v[100:103], v[72:75], v[220:223]
    s_barrier
    v_and_b32 v12, 15, v1
    v_lshlrev_b32 v12, 3, v12
    s_lshl_b32 s41, s38, 9
    s_add_u32 s41, s41, 147456
    v_add_u32 v12, s41, v12
    ds_read_b64 v[16:17], v12 offset:0
    ds_read_b64 v[18:19], v12 offset:128
    ds_read_b64 v[20:21], v12 offset:256
    ds_read_b64 v[22:23], v12 offset:384
    s_mul_i32 s40, s39, 7
    s_lshl_b32 s41, s43, 1
    s_add_u32 s40, s40, s41
    s_lshl_b32 s40, s40, 6
    s_add_u32 s40, s40, 148480
    v_lshrrev_b32 v12, 4, v1
    v_lshlrev_b32 v12, 4, v12
    v_add_u32 v12, s40, v12
    ds_read_b128 v[64:67], v12 offset:0
    ds_read_b128 v[68:71], v12 offset:64
    ds_read_b128 v[72:75], v12 offset:128
    ds_read_b128 v[76:79], v12 offset:192
    ds_read_b128 v[80:83], v12 offset:256
    ds_read_b128 v[84:87], v12 offset:320
    ds_read_b128 v[88:91], v12 offset:384
    s_waitcnt vmcnt(0) lgkmcnt(0)
    v_mov_b32 v24, v17
    v_mov_b32 v26, v19
    v_mov_b32 v28, v21
    v_mov_b32 v30, v23
    v_lshlrev_b32 v36, 16, v224
    v_and_b32 v37, 0xffff0000, v224
    v_lshlrev_b32 v38, 16, v225
    v_and_b32 v39, 0xffff0000, v225
    v_lshlrev_b32 v40, 16, v226
    v_and_b32 v41, 0xffff0000, v226
    v_lshlrev_b32 v42, 16, v227
    v_and_b32 v43, 0xffff0000, v227
    v_lshlrev_b32 v44, 16, v228
    v_and_b32 v45, 0xffff0000, v228
    v_lshlrev_b32 v46, 16, v229
    v_and_b32 v47, 0xffff0000, v229
    v_lshlrev_b32 v48, 16, v230
    v_and_b32 v49, 0xffff0000, v230
    v_lshlrev_b32 v50, 16, v231
    v_and_b32 v51, 0xffff0000, v231
    v_lshlrev_b32 v52, 16, v232
    v_and_b32 v53, 0xffff0000, v232
    v_lshlrev_b32 v54, 16, v233
    v_and_b32 v55, 0xffff0000, v233
    v_lshlrev_b32 v56, 16, v234
    v_and_b32 v57, 0xffff0000, v234
    v_lshlrev_b32 v58, 16, v235
    v_and_b32 v59, 0xffff0000, v235
    v_lshlrev_b32 v60, 16, v236
    v_and_b32 v61, 0xffff0000, v236
    v_lshlrev_b32 v62, 16, v237
    v_and_b32 v63, 0xffff0000, v237
    s_mov_b32 s42, 0
    s_cmp_eq_u32 s39, 0
    s_cbranch_scc0 K3_epi1
    v_pk_fma_f32 v[92:93], v[64:65], v[24:25], v[36:37] op_sel_hi:[1,0,1] neg_lo:[0,1,0] neg_hi:[0,1,0]
    v_pk_fma_f32 v[96:97], v[68:69], v[24:25], v[40:41] op_sel_hi:[1,0,1] neg_lo:[0,1,0] neg_hi:[0,1,0]
    v_pk_fma_f32 v[94:95], v[66:67], v[24:25], v[38:39] op_sel_hi:[1,0,1] neg_lo:[0,1,0] neg_hi:[0,1,0]
    v_pk_fma_f32 v[98:99], v[70:71], v[24:25], v[42:43] op_sel_hi:[1,0,1] neg_lo:[0,1,0] neg_hi:[0,1,0]
    v_pk_fma_f32 v[112:113], v[112:113], v[16:17], v[92:93] op_sel_hi:[1,0,1]
    v_pk_fma_f32 v[116:117], v[116:117], v[16:17], v[96:97] op_sel_hi:[1,0,1]
    v_pk_fma_f32 v[114:115], v[114:115], v[16:17], v[94:95] op_sel_hi:[1,0,1]
    v_pk_fma_f32 v[118:119], v[118:119], v[16:17], v[98:99] op_sel_hi:[1,0,1]
    v_max_f32 v92, 0, v112
    v_max_f32 v96, 0, v116
    v_max_f32 v93, 0, v113
    v_max_f32 v97, 0, v117
    v_max_f32 v94, 0, v114
    v_max_f32 v98, 0, v118
    v_max_f32 v95, 0, v115
    v_max_f32 v99, 0, v119
    v_pk_mul_f32 v[112:113], v[112:113], v[92:93]
    v_pk_mul_f32 v[116:117], v[116:117], v[96:97]
    v_pk_mul_f32 v[114:115], v[114:115], v[94:95]
    v_pk_mul_f32 v[118:119], v[118:119], v[98:99]
    v_cvt_pk_bf16_f32 v100, v112, v113
    v_cvt_pk_bf16_f32 v102, v116, v117
    v_cvt_pk_bf16_f32 v101, v114, v115
    v_cvt_pk_bf16_f32 v103, v118, v119
    buffer_store_dwordx4 v[100:103], v14, s[48:51], s42 offen offset:0 sc1
    v_pk_fma_f32 v[92:93], v[72:73], v[24:25], v[44:45] op_sel_hi:[1,0,1] neg_lo:[0,1,0] neg_hi:[0,1,0]
    v_pk_fma_f32 v[96:97], v[76:77], v[24:25], v[48:49] op_sel_hi:[1,0,1] neg_lo:[0,1,0] neg_hi:[0,1,0]
    v_pk_fma_f32 v[94:95], v[74:75], v[24:25], v[46:47] op_sel_hi:[1,0,1] neg_lo:[0,1,0] neg_hi:[0,1,0]
    v_pk_fma_f32 v[98:99], v[78:79], v[24:25], v[50:51] op_sel_hi:[1,0,1] neg_lo:[0,1,0] neg_hi:[0,1,0]
    v_pk_fma_f32 v[120:121], v[120:121], v[16:17], v[92:93] op_sel_hi:[1,0,1]
    v_pk_fma_f32 v[124:125], v[124:125], v[16:17], v[96:97] op_sel_hi:[1,0,1]
    v_pk_fma_f32 v[122:123], v[122:123], v[16:17], v[94:95] op_sel_hi:[1,0,1]
    v_pk_fma_f32 v[126:127], v[126:127], v[16:17], v[98:99] op_sel_hi:[1,0,1]
    v_max_f32 v92, 0, v120
    v_max_f32 v96, 0, v124
    v_max_f32 v93, 0, v121
    v_max_f32 v97, 0, v125
    v_max_f32 v94, 0, v122
    v_max_f32 v98, 0, v126
    v_max_f32 v95, 0, v123
    v_max_f32 v99, 0, v127
    v_pk_mul_f32 v[120:121], v[120:121], v[92:93]
    v_pk_mul_f32 v[124:125], v[124:125], v[96:97]
    v_pk_mul_f32 v[122:123], v[122:123], v[94:95]
    v_pk_mul_f32 v[126:127], v[126:127], v[98:99]
    v_cvt_pk_bf16_f32 v104, v120, v121
    v_cvt_pk_bf16_f32 v106, v124, v125
    v_cvt_pk_bf16_f32 v105, v122, v123
    v_cvt_pk_bf16_f32 v107, v126, v127
    buffer_store_dwordx4 v[104:107], v14, s[48:51], s42 offen offset:1024 sc1
    v_pk_fma_f32 v[92:93], v[80:81], v[24:25], v[52:53] op_sel_hi:[1,0,1] neg_lo:[0,1,0] neg_hi:[0,1,0]
    v_pk_fma_f32 v[96:97], v[84:85], v[24:25], v[56:57] op_sel_hi:[1,0,1] neg_lo:[0,1,0] neg_hi:[0,1,0]
    v_pk_fma_f32 v[94:95], v[82:83], v[24:25], v[54:55] op_sel_hi:[1,0,1] neg_lo:[0,1,0] neg_hi:[0,1,0]
    v_pk_fma_f32 v[98:99], v[86:87], v[24:25], v[58:59] op_sel_hi:[1,0,1] neg_lo:[0,1,0] neg_hi:[0,1,0]
    v_pk_fma_f32 v[128:129], v[128:129], v[16:17], v[92:93] op_sel_hi:[1,0,1]
    v_pk_fma_f32 v[132:133], v[132:133], v[16:17], v[96:97] op_sel_hi:[1,0,1]
    v_pk_fma_f32 v[130:131], v[130:131], v[16:17], v[94:95] op_sel_hi:[1,0,1]
    v_pk_fma_f32 v[134:135], v[134:135], v[16:17], v[98:99] op_sel_hi:[1,0,1]
    v_max_f32 v92, 0, v128
    v_max_f32 v96, 0, v132
    v_max_f32 v93, 0, v129
    v_max_f32 v97, 0, v133
    v_max_f32 v94, 0, v130
    v_max_f32 v98, 0, v134
    v_max_f32 v95, 0, v131
    v_max_f32 v99, 0, v135
    v_pk_mul_f32 v[128:129], v[128:129], v[92:93]
    v_pk_mul_f32 v[132:133], v[132:133], v[96:97]
    v_pk_mul_f32 v[130:131], v[130:131], v[94:95]
    v_pk_mul_f32 v[134:135], v[134:135], v[98:99]
    v_cvt_pk_bf16_f32 v108, v128, v129
    v_cvt_pk_bf16_f32 v110, v132, v133
    v_cvt_pk_bf16_f32 v109, v130, v131
    v_cvt_pk_bf16_f32 v111, v134, v135
    buffer_store_dwordx4 v[108:111], v14, s[48:51], s42 offen offset:2048 sc1
    v_pk_fma_f32 v[92:93], v[88:89], v[24:25], v[60:61] op_sel_hi:[1,0,1] neg_lo:[0,1,0] neg_hi:[0,1,0]
    v_pk_fma_f32 v[94:95], v[90:91], v[24:25], v[62:63] op_sel_hi:[1,0,1] neg_lo:[0,1,0] neg_hi:[0,1,0]
    v_pk_fma_f32 v[136:137], v[136:137], v[16:17], v[92:93] op_sel_hi:[1,0,1]
    v_pk_fma_f32 v[138:139], v[138:139], v[16:17], v[94:95] op_sel_hi:[1,0,1]
    v_max_f32 v92, 0, v136
    v_max_f32 v93, 0, v137
    v_max_f32 v94, 0, v138
    v_max_f32 v95, 0, v139
    v_pk_mul_f32 v[136:137], v[136:137], v[92:93]
    v_pk_mul_f32 v[138:139], v[138:139], v[94:95]
    v_cvt_pk_bf16_f32 v100, v136, v137
    v_cvt_pk_bf16_f32 v101, v138, v139
    buffer_store_dwordx2 v[100:101], v14, s[48:51], s42 offen offset:3072 sc1
    s_add_u32 s42, s42, 114688
    v_pk_fma_f32 v[92:93], v[64:65], v[26:27], v[36:37] op_sel_hi:[1,0,1] neg_lo:[0,1,0] neg_hi:[0,1,0]
    v_pk_fma_f32 v[96:97], v[68:69], v[26:27], v[40:41] op_sel_hi:[1,0,1] neg_lo:[0,1,0] neg_hi:[0,1,0]
    v_pk_fma_f32 v[94:95], v[66:67], v[26:27], v[38:39] op_sel_hi:[1,0,1] neg_lo:[0,1,0] neg_hi:[0,1,0]
    v_pk_fma_f32 v[98:99], v[70:71], v[26:27], v[42:43] op_sel_hi:[1,0,1] neg_lo:[0,1,0] neg_hi:[0,1,0]
    v_pk_fma_f32 v[140:141], v[140:141], v[18:19], v[92:93] op_sel_hi:[1,0,1]
    v_pk_fma_f32 v[144:145], v[144:145], v[18:19], v[96:97] op_sel_hi:[1,0,1]
    v_pk_fma_f32 v[142:143], v[142:143], v[18:19], v[94:95] op_sel_hi:[1,0,1]
    v_pk_fma_f32 v[146:147], v[146:147], v[18:19], v[98:99] op_sel_hi:[1,0,1]
    v_max_f32 v92, 0, v140
    v_max_f32 v96, 0, v144
    v_max_f32 v93, 0, v141
    v_max_f32 v97, 0, v145
    v_max_f32 v94, 0, v142
    v_max_f32 v98, 0, v146
    v_max_f32 v95, 0, v143
    v_max_f32 v99, 0, v147
    v_pk_mul_f32 v[140:141], v[140:141], v[92:93]
    v_pk_mul_f32 v[144:145], v[144:145], v[96:97]
    v_pk_mul_f32 v[142:143], v[142:143], v[94:95]
    v_pk_mul_f32 v[146:147], v[146:147], v[98:99]
    v_cvt_pk_bf16_f32 v104, v140, v141
    v_cvt_pk_bf16_f32 v106, v144, v145
    v_cvt_pk_bf16_f32 v105, v142, v143
    v_cvt_pk_bf16_f32 v107, v146, v147
    buffer_store_dwordx4 v[104:107], v14, s[48:51], s42 offen offset:0 sc1
    v_pk_fma_f32 v[92:93], v[72:73], v[26:27], v[44:45] op_sel_hi:[1,0,1] neg_lo:[0,1,0] neg_hi:[0,1,0]
    v_pk_fma_f32 v[96:97], v[76:77], v[26:27], v[48:49] op_sel_hi:[1,0,1] neg_lo:[0,1,0] neg_hi:[0,1,0]
    v_pk_fma_f32 v[94:95], v[74:75], v[26:27], v[46:47] op_sel_hi:[1,0,1] neg_lo:[0,1,0] neg_hi:[0,1,0]
    v_pk_fma_f32 v[98:99], v[78:79], v[26:27], v[50:51] op_sel_hi:[1,0,1] neg_lo:[0,1,0] neg_hi:[0,1,0]
    v_pk_fma_f32 v[148:149], v[148:149], v[18:19], v[92:93] op_sel_hi:[1,0,1]
    v_pk_fma_f32 v[152:153], v[152:153], v[18:19], v[96:97] op_sel_hi:[1,0,1]
    v_pk_fma_f32 v[150:151], v[150:151], v[18:19], v[94:95] op_sel_hi:[1,0,1]
    v_pk_fma_f32 v[154:155], v[154:155], v[18:19], v[98:99] op_sel_hi:[1,0,1]
    v_max_f32 v92, 0, v148
    v_max_f32 v96, 0, v152
    v_max_f32 v93, 0, v149
    v_max_f32 v97, 0, v153
    v_max_f32 v94, 0, v150
    v_max_f32 v98, 0, v154
    v_max_f32 v95, 0, v151
    v_max_f32 v99, 0, v155
    v_pk_mul_f32 v[148:149], v[148:149], v[92:93]
    v_pk_mul_f32 v[152:153], v[152:153], v[96:97]
    v_pk_mul_f32 v[150:151], v[150:151], v[94:95]
    v_pk_mul_f32 v[154:155], v[154:155], v[98:99]
    v_cvt_pk_bf16_f32 v108, v148, v149
    v_cvt_pk_bf16_f32 v110, v152, v153
    v_cvt_pk_bf16_f32 v109, v150, v151
    v_cvt_pk_bf16_f32 v111, v154, v155
    buffer_store_dwordx4 v[108:111], v14, s[48:51], s42 offen offset:1024 sc1
    v_pk_fma_f32 v[92:93], v[80:81], v[26:27], v[52:53] op_sel_hi:[1,0,1] neg_lo:[0,1,0] neg_hi:[0,1,0]
    v_pk_fma_f32 v[96:97], v[84:85], v[26:27], v[56:57] op_sel_hi:[1,0,1] neg_lo:[0,1,0] neg_hi:[0,1,0]
    v_pk_fma_f32 v[94:95], v[82:83], v[26:27], v[54:55] op_sel_hi:[1,0,1] neg_lo:[0,1,0] neg_hi:[0,1,0]
    v_pk_fma_f32 v[98:99], v[86:87], v[26:27], v[58:59] op_sel_hi:[1,0,1] neg_lo:[0,1,0] neg_hi:[0,1,0]
    v_pk_fma_f32 v[156:157], v[156:157], v[18:19], v[92:93] op_sel_hi:[1,0,1]
    v_pk_fma_f32 v[160:161], v[160:161], v[18:19], v[96:97] op_sel_hi:[1,0,1]
    v_pk_fma_f32 v[158:159], v[158:159], v[18:19], v[94:95] op_sel_hi:[1,0,1]
    v_pk_fma_f32 v[162:163], v[162:163], v[18:19], v[98:99] op_sel_hi:[1,0,1]
    v_max_f32 v92, 0, v156
    v_max_f32 v96, 0, v160
    v_max_f32 v93, 0, v157
    v_max_f32 v97, 0, v161
    v_max_f32 v94, 0, v158
    v_max_f32 v98, 0, v162
    v_max_f32 v95, 0, v159
    v_max_f32 v99, 0, v163
    v_pk_mul_f32 v[156:157], v[156:157], v[92:93]
    v_pk_mul_f32 v[160:161], v[160:161], v[96:97]
    v_pk_mul_f32 v[158:159], v[158:159], v[94:95]
    v_pk_mul_f32 v[162:163], v[162:163], v[98:99]
    v_cvt_pk_bf16_f32 v100, v156, v157
    v_cvt_pk_bf16_f32 v102, v160, v161
    v_cvt_pk_bf16_f32 v101, v158, v159
    v_cvt_pk_bf16_f32 v103, v162, v163
    buffer_store_dwordx4 v[100:103], v14, s[48:51], s42 offen offset:2048 sc1
    v_pk_fma_f32 v[92:93], v[88:89], v[26:27], v[60:61] op_sel_hi:[1,0,1] neg_lo:[0,1,0] neg_hi:[0,1,0]
    v_pk_fma_f32 v[94:95], v[90:91], v[26:27], v[62:63] op_sel_hi:[1,0,1] neg_lo:[0,1,0] neg_hi:[0,1,0]
    v_pk_fma_f32 v[164:165], v[164:165], v[18:19], v[92:93] op_sel_hi:[1,0,1]
    v_pk_fma_f32 v[166:167], v[166:167], v[18:19], v[94:95] op_sel_hi:[1,0,1]
    v_max_f32 v92, 0, v164
    v_max_f32 v93, 0, v165
    v_max_f32 v94, 0, v166
    v_max_f32 v95, 0, v167
    v_pk_mul_f32 v[164:165], v[164:165], v[92:93]
    v_pk_mul_f32 v[166:167], v[166:167], v[94:95]
    v_cvt_pk_bf16_f32 v104, v164, v165
    v_cvt_pk_bf16_f32 v105, v166, v167
    buffer_store_dwordx2 v[104:105], v14, s[48:51], s42 offen offset:3072 sc1
    s_add_u32 s42, s42, 114688
    v_pk_fma_f32 v[92:93], v[64:65], v[28:29], v[36:37] op_sel_hi:[1,0,1] neg_lo:[0,1,0] neg_hi:[0,1,0]
    v_pk_fma_f32 v[96:97], v[68:69], v[28:29], v[40:41] op_sel_hi:[1,0,1] neg_lo:[0,1,0] neg_hi:[0,1,0]
    v_pk_fma_f32 v[94:95], v[66:67], v[28:29], v[38:39] op_sel_hi:[1,0,1] neg_lo:[0,1,0] neg_hi:[0,1,0]
    v_pk_fma_f32 v[98:99], v[70:71], v[28:29], v[42:43] op_sel_hi:[1,0,1] neg_lo:[0,1,0] neg_hi:[0,1,0]
    v_pk_fma_f32 v[168:169], v[168:169], v[20:21], v[92:93] op_sel_hi:[1,0,1]
    v_pk_fma_f32 v[172:173], v[172:173], v[20:21], v[96:97] op_sel_hi:[1,0,1]
    v_pk_fma_f32 v[170:171], v[170:171], v[20:21], v[94:95] op_sel_hi:[1,0,1]
    v_pk_fma_f32 v[174:175], v[174:175], v[20:21], v[98:99] op_sel_hi:[1,0,1]
    v_max_f32 v92, 0, v168
    v_max_f32 v96, 0, v172
    v_max_f32 v93, 0, v169
    v_max_f32 v97, 0, v173
    v_max_f32 v94, 0, v170
    v_max_f32 v98, 0, v174
    v_max_f32 v95, 0, v171
    v_max_f32 v99, 0, v175
    v_pk_mul_f32 v[168:169], v[168:169], v[92:93]
    v_pk_mul_f32 v[172:173], v[172:173], v[96:97]
    v_pk_mul_f32 v[170:171], v[170:171], v[94:95]
    v_pk_mul_f32 v[174:175], v[174:175], v[98:99]
    v_cvt_pk_bf16_f32 v108, v168, v169
    v_cvt_pk_bf16_f32 v110, v172, v173
    v_cvt_pk_bf16_f32 v109, v170, v171
    v_cvt_pk_bf16_f32 v111, v174, v175
    buffer_store_dwordx4 v[108:111], v14, s[48:51], s42 offen offset:0 sc1
    v_pk_fma_f32 v[92:93], v[72:73], v[28:29], v[44:45] op_sel_hi:[1,0,1] neg_lo:[0,1,0] neg_hi:[0,1,0]
    v_pk_fma_f32 v[96:97], v[76:77], v[28:29], v[48:49] op_sel_hi:[1,0,1] neg_lo:[0,1,0] neg_hi:[0,1,0]
    v_pk_fma_f32 v[94:95], v[74:75], v[28:29], v[46:47] op_sel_hi:[1,0,1] neg_lo:[0,1,0] neg_hi:[0,1,0]
    v_pk_fma_f32 v[98:99], v[78:79], v[28:29], v[50:51] op_sel_hi:[1,0,1] neg_lo:[0,1,0] neg_hi:[0,1,0]
    v_pk_fma_f32 v[176:177], v[176:177], v[20:21], v[92:93] op_sel_hi:[1,0,1]
    v_pk_fma_f32 v[180:181], v[180:181], v[20:21], v[96:97] op_sel_hi:[1,0,1]
    v_pk_fma_f32 v[178:179], v[178:179], v[20:21], v[94:95] op_sel_hi:[1,0,1]
    v_pk_fma_f32 v[182:183], v[182:183], v[20:21], v[98:99] op_sel_hi:[1,0,1]
    v_max_f32 v92, 0, v176
    v_max_f32 v96, 0, v180
    v_max_f32 v93, 0, v177
    v_max_f32 v97, 0, v181
    v_max_f32 v94, 0, v178
    v_max_f32 v98, 0, v182
    v_max_f32 v95, 0, v179
    v_max_f32 v99, 0, v183
    v_pk_mul_f32 v[176:177], v[176:177], v[92:93]
    v_pk_mul_f32 v[180:181], v[180:181], v[96:97]
    v_pk_mul_f32 v[178:179], v[178:179], v[94:95]
    v_pk_mul_f32 v[182:183], v[182:183], v[98:99]
    v_cvt_pk_bf16_f32 v100, v176, v177
    v_cvt_pk_bf16_f32 v102, v180, v181
    v_cvt_pk_bf16_f32 v101, v178, v179
    v_cvt_pk_bf16_f32 v103, v182, v183
    buffer_store_dwordx4 v[100:103], v14, s[48:51], s42 offen offset:1024 sc1
    v_pk_fma_f32 v[92:93], v[80:81], v[28:29], v[52:53] op_sel_hi:[1,0,1] neg_lo:[0,1,0] neg_hi:[0,1,0]
    v_pk_fma_f32 v[96:97], v[84:85], v[28:29], v[56:57] op_sel_hi:[1,0,1] neg_lo:[0,1,0] neg_hi:[0,1,0]
    v_pk_fma_f32 v[94:95], v[82:83], v[28:29], v[54:55] op_sel_hi:[1,0,1] neg_lo:[0,1,0] neg_hi:[0,1,0]
    v_pk_fma_f32 v[98:99], v[86:87], v[28:29], v[58:59] op_sel_hi:[1,0,1] neg_lo:[0,1,0] neg_hi:[0,1,0]
    v_pk_fma_f32 v[184:185], v[184:185], v[20:21], v[92:93] op_sel_hi:[1,0,1]
    v_pk_fma_f32 v[188:189], v[188:189], v[20:21], v[96:97] op_sel_hi:[1,0,1]
    v_pk_fma_f32 v[186:187], v[186:187], v[20:21], v[94:95] op_sel_hi:[1,0,1]
    v_pk_fma_f32 v[190:191], v[190:191], v[20:21], v[98:99] op_sel_hi:[1,0,1]
    v_max_f32 v92, 0, v184
    v_max_f32 v96, 0, v188
    v_max_f32 v93, 0, v185
    v_max_f32 v97, 0, v189
    v_max_f32 v94, 0, v186
    v_max_f32 v98, 0, v190
    v_max_f32 v95, 0, v187
    v_max_f32 v99, 0, v191
    v_pk_mul_f32 v[184:185], v[184:185], v[92:93]
    v_pk_mul_f32 v[188:189], v[188:189], v[96:97]
    v_pk_mul_f32 v[186:187], v[186:187], v[94:95]
    v_pk_mul_f32 v[190:191], v[190:191], v[98:99]
    v_cvt_pk_bf16_f32 v104, v184, v185
    v_cvt_pk_bf16_f32 v106, v188, v189
    v_cvt_pk_bf16_f32 v105, v186, v187
    v_cvt_pk_bf16_f32 v107, v190, v191
    buffer_store_dwordx4 v[104:107], v14, s[48:51], s42 offen offset:2048 sc1
    v_pk_fma_f32 v[92:93], v[88:89], v[28:29], v[60:61] op_sel_hi:[1,0,1] neg_lo:[0,1,0] neg_hi:[0,1,0]
    v_pk_fma_f32 v[94:95], v[90:91], v[28:29], v[62:63] op_sel_hi:[1,0,1] neg_lo:[0,1,0] neg_hi:[0,1,0]
    v_pk_fma_f32 v[192:193], v[192:193], v[20:21], v[92:93] op_sel_hi:[1,0,1]
    v_pk_fma_f32 v[194:195], v[194:195], v[20:21], v[94:95] op_sel_hi:[1,0,1]
    v_max_f32 v92, 0, v192
    v_max_f32 v93, 0, v193
    v_max_f32 v94, 0, v194
    v_max_f32 v95, 0, v195
    v_pk_mul_f32 v[192:193], v[192:193], v[92:93]
    v_pk_mul_f32 v[194:195], v[194:195], v[94:95]
    v_cvt_pk_bf16_f32 v108, v192, v193
    v_cvt_pk_bf16_f32 v109, v194, v195
    buffer_store_dwordx2 v[108:109], v14, s[48:51], s42 offen offset:3072 sc1
    s_add_u32 s42, s42, 114688
    v_pk_fma_f32 v[92:93], v[64:65], v[30:31], v[36:37] op_sel_hi:[1,0,1] neg_lo:[0,1,0] neg_hi:[0,1,0]
    v_pk_fma_f32 v[96:97], v[68:69], v[30:31], v[40:41] op_sel_hi:[1,0,1] neg_lo:[0,1,0] neg_hi:[0,1,0]
    v_pk_fma_f32 v[94:95], v[66:67], v[30:31], v[38:39] op_sel_hi:[1,0,1] neg_lo:[0,1,0] neg_hi:[0,1,0]
    v_pk_fma_f32 v[98:99], v[70:71], v[30:31], v[42:43] op_sel_hi:[1,0,1] neg_lo:[0,1,0] neg_hi:[0,1,0]
    v_pk_fma_f32 v[196:197], v[196:197], v[22:23], v[92:93] op_sel_hi:[1,0,1]
    v_pk_fma_f32 v[200:201], v[200:201], v[22:23], v[96:97] op_sel_hi:[1,0,1]
    v_pk_fma_f32 v[198:199], v[198:199], v[22:23], v[94:95] op_sel_hi:[1,0,1]
    v_pk_fma_f32 v[202:203], v[202:203], v[22:23], v[98:99] op_sel_hi:[1,0,1]
    v_max_f32 v92, 0, v196
    v_max_f32 v96, 0, v200
    v_max_f32 v93, 0, v197
    v_max_f32 v97, 0, v201
    v_max_f32 v94, 0, v198
    v_max_f32 v98, 0, v202
    v_max_f32 v95, 0, v199
    v_max_f32 v99, 0, v203
    v_pk_mul_f32 v[196:197], v[196:197], v[92:93]
    v_pk_mul_f32 v[200:201], v[200:201], v[96:97]
    v_pk_mul_f32 v[198:199], v[198:199], v[94:95]
    v_pk_mul_f32 v[202:203], v[202:203], v[98:99]
    v_cvt_pk_bf16_f32 v100, v196, v197
    v_cvt_pk_bf16_f32 v102, v200, v201
    v_cvt_pk_bf16_f32 v101, v198, v199
    v_cvt_pk_bf16_f32 v103, v202, v203
    buffer_store_dwordx4 v[100:103], v14, s[48:51], s42 offen offset:0 sc1
    v_pk_fma_f32 v[92:93], v[72:73], v[30:31], v[44:45] op_sel_hi:[1,0,1] neg_lo:[0,1,0] neg_hi:[0,1,0]
    v_pk_fma_f32 v[96:97], v[76:77], v[30:31], v[48:49] op_sel_hi:[1,0,1] neg_lo:[0,1,0] neg_hi:[0,1,0]
    v_pk_fma_f32 v[94:95], v[74:75], v[30:31], v[46:47] op_sel_hi:[1,0,1] neg_lo:[0,1,0] neg_hi:[0,1,0]
    v_pk_fma_f32 v[98:99], v[78:79], v[30:31], v[50:51] op_sel_hi:[1,0,1] neg_lo:[0,1,0] neg_hi:[0,1,0]
    v_pk_fma_f32 v[204:205], v[204:205], v[22:23], v[92:93] op_sel_hi:[1,0,1]
    v_pk_fma_f32 v[208:209], v[208:209], v[22:23], v[96:97] op_sel_hi:[1,0,1]
    v_pk_fma_f32 v[206:207], v[206:207], v[22:23], v[94:95] op_sel_hi:[1,0,1]
    v_pk_fma_f32 v[210:211], v[210:211], v[22:23], v[98:99] op_sel_hi:[1,0,1]
    v_max_f32 v92, 0, v204
    v_max_f32 v96, 0, v208
    v_max_f32 v93, 0, v205
    v_max_f32 v97, 0, v209
    v_max_f32 v94, 0, v206
    v_max_f32 v98, 0, v210
    v_max_f32 v95, 0, v207
    v_max_f32 v99, 0, v211
    v_pk_mul_f32 v[204:205], v[204:205], v[92:93]
    v_pk_mul_f32 v[208:209], v[208:209], v[96:97]
    v_pk_mul_f32 v[206:207], v[206:207], v[94:95]
    v_pk_mul_f32 v[210:211], v[210:211], v[98:99]
    v_cvt_pk_bf16_f32 v104, v204, v205
    v_cvt_pk_bf16_f32 v106, v208, v209
    v_cvt_pk_bf16_f32 v105, v206, v207
    v_cvt_pk_bf16_f32 v107, v210, v211
    buffer_store_dwordx4 v[104:107], v14, s[48:51], s42 offen offset:1024 sc1
    v_pk_fma_f32 v[92:93], v[80:81], v[30:31], v[52:53] op_sel_hi:[1,0,1] neg_lo:[0,1,0] neg_hi:[0,1,0]
    v_pk_fma_f32 v[96:97], v[84:85], v[30:31], v[56:57] op_sel_hi:[1,0,1] neg_lo:[0,1,0] neg_hi:[0,1,0]
    v_pk_fma_f32 v[94:95], v[82:83], v[30:31], v[54:55] op_sel_hi:[1,0,1] neg_lo:[0,1,0] neg_hi:[0,1,0]
    v_pk_fma_f32 v[98:99], v[86:87], v[30:31], v[58:59] op_sel_hi:[1,0,1] neg_lo:[0,1,0] neg_hi:[0,1,0]
    v_pk_fma_f32 v[212:213], v[212:213], v[22:23], v[92:93] op_sel_hi:[1,0,1]
    v_pk_fma_f32 v[216:217], v[216:217], v[22:23], v[96:97] op_sel_hi:[1,0,1]
    v_pk_fma_f32 v[214:215], v[214:215], v[22:23], v[94:95] op_sel_hi:[1,0,1]
    v_pk_fma_f32 v[218:219], v[218:219], v[22:23], v[98:99] op_sel_hi:[1,0,1]
    v_max_f32 v92, 0, v212
    v_max_f32 v96, 0, v216
    v_max_f32 v93, 0, v213
    v_max_f32 v97, 0, v217
    v_max_f32 v94, 0, v214
    v_max_f32 v98, 0, v218
    v_max_f32 v95, 0, v215
    v_max_f32 v99, 0, v219
    v_pk_mul_f32 v[212:213], v[212:213], v[92:93]
    v_pk_mul_f32 v[216:217], v[216:217], v[96:97]
    v_pk_mul_f32 v[214:215], v[214:215], v[94:95]
    v_pk_mul_f32 v[218:219], v[218:219], v[98:99]
    v_cvt_pk_bf16_f32 v108, v212, v213
    v_cvt_pk_bf16_f32 v110, v216, v217
    v_cvt_pk_bf16_f32 v109, v214, v215
    v_cvt_pk_bf16_f32 v111, v218, v219
    buffer_store_dwordx4 v[108:111], v14, s[48:51], s42 offen offset:2048 sc1
    v_pk_fma_f32 v[92:93], v[88:89], v[30:31], v[60:61] op_sel_hi:[1,0,1] neg_lo:[0,1,0] neg_hi:[0,1,0]
    v_pk_fma_f32 v[94:95], v[90:91], v[30:31], v[62:63] op_sel_hi:[1,0,1] neg_lo:[0,1,0] neg_hi:[0,1,0]
    v_pk_fma_f32 v[220:221], v[220:221], v[22:23], v[92:93] op_sel_hi:[1,0,1]
    v_pk_fma_f32 v[222:223], v[222:223], v[22:23], v[94:95] op_sel_hi:[1,0,1]
    v_max_f32 v92, 0, v220
    v_max_f32 v93, 0, v221
    v_max_f32 v94, 0, v222
    v_max_f32 v95, 0, v223
    v_pk_mul_f32 v[220:221], v[220:221], v[92:93]
    v_pk_mul_f32 v[222:223], v[222:223], v[94:95]
    v_cvt_pk_bf16_f32 v100, v220, v221
    v_cvt_pk_bf16_f32 v101, v222, v223
    buffer_store_dwordx2 v[100:101], v14, s[48:51], s42 offen offset:3072 sc1
    s_branch K3_cend
K3_epi1:
    v_pk_fma_f32 v[92:93], v[64:65], v[24:25], v[36:37] op_sel_hi:[1,0,1] neg_lo:[0,1,0] neg_hi:[0,1,0]
    v_pk_fma_f32 v[94:95], v[66:67], v[24:25], v[38:39] op_sel_hi:[1,0,1] neg_lo:[0,1,0] neg_hi:[0,1,0]
    v_pk_fma_f32 v[112:113], v[112:113], v[16:17], v[92:93] op_sel_hi:[1,0,1]
    v_pk_fma_f32 v[114:115], v[114:115], v[16:17], v[94:95] op_sel_hi:[1,0,1]
    v_max_f32 v92, 0, v112
    v_max_f32 v93, 0, v113
    v_max_f32 v94, 0, v114
    v_max_f32 v95, 0, v115
    v_pk_mul_f32 v[112:113], v[112:113], v[92:93]
    v_pk_mul_f32 v[114:115], v[114:115], v[94:95]
    v_cvt_pk_bf16_f32 v100, v112, v113
    v_cvt_pk_bf16_f32 v101, v114, v115
    buffer_store_dwordx2 v[100:101], v14, s[48:51], s42 offen offset:8 sc1
    v_pk_fma_f32 v[92:93], v[68:69], v[24:25], v[40:41] op_sel_hi:[1,0,1] neg_lo:[0,1,0] neg_hi:[0,1,0]
    v_pk_fma_f32 v[96:97], v[72:73], v[24:25], v[44:45] op_sel_hi:[1,0,1] neg_lo:[0,1,0] neg_hi:[0,1,0]
    v_pk_fma_f32 v[94:95], v[70:71], v[24:25], v[42:43] op_sel_hi:[1,0,1] neg_lo:[0,1,0] neg_hi:[0,1,0]
    v_pk_fma_f32 v[98:99], v[74:75], v[24:25], v[46:47] op_sel_hi:[1,0,1] neg_lo:[0,1,0] neg_hi:[0,1,0]
    v_pk_fma_f32 v[116:117], v[116:117], v[16:17], v[92:93] op_sel_hi:[1,0,1]
    v_pk_fma_f32 v[120:121], v[120:121], v[16:17], v[96:97] op_sel_hi:[1,0,1]
    v_pk_fma_f32 v[118:119], v[118:119], v[16:17], v[94:95] op_sel_hi:[1,0,1]
    v_pk_fma_f32 v[122:123], v[122:123], v[16:17], v[98:99] op_sel_hi:[1,0,1]
    v_max_f32 v92, 0, v116
    v_max_f32 v96, 0, v120
    v_max_f32 v93, 0, v117
    v_max_f32 v97, 0, v121
    v_max_f32 v94, 0, v118
    v_max_f32 v98, 0, v122
    v_max_f32 v95, 0, v119
    v_max_f32 v99, 0, v123
    v_pk_mul_f32 v[116:117], v[116:117], v[92:93]
    v_pk_mul_f32 v[120:121], v[120:121], v[96:97]
    v_pk_mul_f32 v[118:119], v[118:119], v[94:95]
    v_pk_mul_f32 v[122:123], v[122:123], v[98:99]
    v_cvt_pk_bf16_f32 v104, v116, v117
    v_cvt_pk_bf16_f32 v106, v120, v121
    v_cvt_pk_bf16_f32 v105, v118, v119
    v_cvt_pk_bf16_f32 v107, v122, v123
    buffer_store_dwordx4 v[104:107], v14, s[48:51], s42 offen offset:1024 sc1
    v_pk_fma_f32 v[92:93], v[76:77], v[24:25], v[48:49] op_sel_hi:[1,0,1] neg_lo:[0,1,0] neg_hi:[0,1,0]
    v_pk_fma_f32 v[96:97], v[80:81], v[24:25], v[52:53] op_sel_hi:[1,0,1] neg_lo:[0,1,0] neg_hi:[0,1,0]
    v_pk_fma_f32 v[94:95], v[78:79], v[24:25], v[50:51] op_sel_hi:[1,0,1] neg_lo:[0,1,0] neg_hi:[0,1,0]
    v_pk_fma_f32 v[98:99], v[82:83], v[24:25], v[54:55] op_sel_hi:[1,0,1] neg_lo:[0,1,0] neg_hi:[0,1,0]
    v_pk_fma_f32 v[124:125], v[124:125], v[16:17], v[92:93] op_sel_hi:[1,0,1]
    v_pk_fma_f32 v[128:129], v[128:129], v[16:17], v[96:97] op_sel_hi:[1,0,1]
    v_pk_fma_f32 v[126:127], v[126:127], v[16:17], v[94:95] op_sel_hi:[1,0,1]
    v_pk_fma_f32 v[130:131], v[130:131], v[16:17], v[98:99] op_sel_hi:[1,0,1]
    v_max_f32 v92, 0, v124
    v_max_f32 v96, 0, v128
    v_max_f32 v93, 0, v125
    v_max_f32 v97, 0, v129
    v_max_f32 v94, 0, v126
    v_max_f32 v98, 0, v130
    v_max_f32 v95, 0, v127
    v_max_f32 v99, 0, v131
    v_pk_mul_f32 v[124:125], v[124:125], v[92:93]
    v_pk_mul_f32 v[128:129], v[128:129], v[96:97]
    v_pk_mul_f32 v[126:127], v[126:127], v[94:95]
    v_pk_mul_f32 v[130:131], v[130:131], v[98:99]
    v_cvt_pk_bf16_f32 v108, v124, v125
    v_cvt_pk_bf16_f32 v110, v128, v129
    v_cvt_pk_bf16_f32 v109, v126, v127
    v_cvt_pk_bf16_f32 v111, v130, v131
    buffer_store_dwordx4 v[108:111], v14, s[48:51], s42 offen offset:2048 sc1
    v_pk_fma_f32 v[92:93], v[84:85], v[24:25], v[56:57] op_sel_hi:[1,0,1] neg_lo:[0,1,0] neg_hi:[0,1,0]
    v_pk_fma_f32 v[96:97], v[88:89], v[24:25], v[60:61] op_sel_hi:[1,0,1] neg_lo:[0,1,0] neg_hi:[0,1,0]
    v_pk_fma_f32 v[94:95], v[86:87], v[24:25], v[58:59] op_sel_hi:[1,0,1] neg_lo:[0,1,0] neg_hi:[0,1,0]
    v_pk_fma_f32 v[98:99], v[90:91], v[24:25], v[62:63] op_sel_hi:[1,0,1] neg_lo:[0,1,0] neg_hi:[0,1,0]
    v_pk_fma_f32 v[132:133], v[132:133], v[16:17], v[92:93] op_sel_hi:[1,0,1]
    v_pk_fma_f32 v[136:137], v[136:137], v[16:17], v[96:97] op_sel_hi:[1,0,1]
    v_pk_fma_f32 v[134:135], v[134:135], v[16:17], v[94:95] op_sel_hi:[1,0,1]
    v_pk_fma_f32 v[138:139], v[138:139], v[16:17], v[98:99] op_sel_hi:[1,0,1]
    v_max_f32 v92, 0, v132
    v_max_f32 v96, 0, v136
    v_max_f32 v93, 0, v133
    v_max_f32 v97, 0, v137
    v_max_f32 v94, 0, v134
    v_max_f32 v98, 0, v138
    v_max_f32 v95, 0, v135
    v_max_f32 v99, 0, v139
    v_pk_mul_f32 v[132:133], v[132:133], v[92:93]
    v_pk_mul_f32 v[136:137], v[136:137], v[96:97]
    v_pk_mul_f32 v[134:135], v[134:135], v[94:95]
    v_pk_mul_f32 v[138:139], v[138:139], v[98:99]
    v_cvt_pk_bf16_f32 v100, v132, v133
    v_cvt_pk_bf16_f32 v102, v136, v137
    v_cvt_pk_bf16_f32 v101, v134, v135
    v_cvt_pk_bf16_f32 v103, v138, v139
    buffer_store_dwordx4 v[100:103], v14, s[48:51], s42 offen offset:3072 sc1
    s_add_u32 s42, s42, 114688
    v_pk_fma_f32 v[92:93], v[64:65], v[26:27], v[36:37] op_sel_hi:[1,0,1] neg_lo:[0,1,0] neg_hi:[0,1,0]
    v_pk_fma_f32 v[94:95], v[66:67], v[26:27], v[38:39] op_sel_hi:[1,0,1] neg_lo:[0,1,0] neg_hi:[0,1,0]
    v_pk_fma_f32 v[140:141], v[140:141], v[18:19], v[92:93] op_sel_hi:[1,0,1]
    v_pk_fma_f32 v[142:143], v[142:143], v[18:19], v[94:95] op_sel_hi:[1,0,1]
    v_max_f32 v92, 0, v140
    v_max_f32 v93, 0, v141
    v_max_f32 v94, 0, v142
    v_max_f32 v95, 0, v143
    v_pk_mul_f32 v[140:141], v[140:141], v[92:93]
    v_pk_mul_f32 v[142:143], v[142:143], v[94:95]
    v_cvt_pk_bf16_f32 v100, v140, v141
    v_cvt_pk_bf16_f32 v101, v142, v143
    buffer_store_dwordx2 v[100:101], v14, s[48:51], s42 offen offset:8 sc1
    v_pk_fma_f32 v[92:93], v[68:69], v[26:27], v[40:41] op_sel_hi:[1,0,1] neg_lo:[0,1,0] neg_hi:[0,1,0]
    v_pk_fma_f32 v[96:97], v[72:73], v[26:27], v[44:45] op_sel_hi:[1,0,1] neg_lo:[0,1,0] neg_hi:[0,1,0]
    v_pk_fma_f32 v[94:95], v[70:71], v[26:27], v[42:43] op_sel_hi:[1,0,1] neg_lo:[0,1,0] neg_hi:[0,1,0]
    v_pk_fma_f32 v[98:99], v[74:75], v[26:27], v[46:47] op_sel_hi:[1,0,1] neg_lo:[0,1,0] neg_hi:[0,1,0]
    v_pk_fma_f32 v[144:145], v[144:145], v[18:19], v[92:93] op_sel_hi:[1,0,1]
    v_pk_fma_f32 v[148:149], v[148:149], v[18:19], v[96:97] op_sel_hi:[1,0,1]
    v_pk_fma_f32 v[146:147], v[146:147], v[18:19], v[94:95] op_sel_hi:[1,0,1]
    v_pk_fma_f32 v[150:151], v[150:151], v[18:19], v[98:99] op_sel_hi:[1,0,1]
    v_max_f32 v92, 0, v144
    v_max_f32 v96, 0, v148
    v_max_f32 v93, 0, v145
    v_max_f32 v97, 0, v149
    v_max_f32 v94, 0, v146
    v_max_f32 v98, 0, v150
    v_max_f32 v95, 0, v147
    v_max_f32 v99, 0, v151
    v_pk_mul_f32 v[144:145], v[144:145], v[92:93]
    v_pk_mul_f32 v[148:149], v[148:149], v[96:97]
    v_pk_mul_f32 v[146:147], v[146:147], v[94:95]
    v_pk_mul_f32 v[150:151], v[150:151], v[98:99]
    v_cvt_pk_bf16_f32 v104, v144, v145
    v_cvt_pk_bf16_f32 v106, v148, v149
    v_cvt_pk_bf16_f32 v105, v146, v147
    v_cvt_pk_bf16_f32 v107, v150, v151
    buffer_store_dwordx4 v[104:107], v14, s[48:51], s42 offen offset:1024 sc1
    v_pk_fma_f32 v[92:93], v[76:77], v[26:27], v[48:49] op_sel_hi:[1,0,1] neg_lo:[0,1,0] neg_hi:[0,1,0]
    v_pk_fma_f32 v[96:97], v[80:81], v[26:27], v[52:53] op_sel_hi:[1,0,1] neg_lo:[0,1,0] neg_hi:[0,1,0]
    v_pk_fma_f32 v[94:95], v[78:79], v[26:27], v[50:51] op_sel_hi:[1,0,1] neg_lo:[0,1,0] neg_hi:[0,1,0]
    v_pk_fma_f32 v[98:99], v[82:83], v[26:27], v[54:55] op_sel_hi:[1,0,1] neg_lo:[0,1,0] neg_hi:[0,1,0]
    v_pk_fma_f32 v[152:153], v[152:153], v[18:19], v[92:93] op_sel_hi:[1,0,1]
    v_pk_fma_f32 v[156:157], v[156:157], v[18:19], v[96:97] op_sel_hi:[1,0,1]
    v_pk_fma_f32 v[154:155], v[154:155], v[18:19], v[94:95] op_sel_hi:[1,0,1]
    v_pk_fma_f32 v[158:159], v[158:159], v[18:19], v[98:99] op_sel_hi:[1,0,1]
    v_max_f32 v92, 0, v152
    v_max_f32 v96, 0, v156
    v_max_f32 v93, 0, v153
    v_max_f32 v97, 0, v157
    v_max_f32 v94, 0, v154
    v_max_f32 v98, 0, v158
    v_max_f32 v95, 0, v155
    v_max_f32 v99, 0, v159
    v_pk_mul_f32 v[152:153], v[152:153], v[92:93]
    v_pk_mul_f32 v[156:157], v[156:157], v[96:97]
    v_pk_mul_f32 v[154:155], v[154:155], v[94:95]
    v_pk_mul_f32 v[158:159], v[158:159], v[98:99]
    v_cvt_pk_bf16_f32 v108, v152, v153
    v_cvt_pk_bf16_f32 v110, v156, v157
    v_cvt_pk_bf16_f32 v109, v154, v155
    v_cvt_pk_bf16_f32 v111, v158, v159
    buffer_store_dwordx4 v[108:111], v14, s[48:51], s42 offen offset:2048 sc1
    v_pk_fma_f32 v[92:93], v[84:85], v[26:27], v[56:57] op_sel_hi:[1,0,1] neg_lo:[0,1,0] neg_hi:[0,1,0]
    v_pk_fma_f32 v[96:97], v[88:89], v[26:27], v[60:61] op_sel_hi:[1,0,1] neg_lo:[0,1,0] neg_hi:[0,1,0]
    v_pk_fma_f32 v[94:95], v[86:87], v[26:27], v[58:59] op_sel_hi:[1,0,1] neg_lo:[0,1,0] neg_hi:[0,1,0]
    v_pk_fma_f32 v[98:99], v[90:91], v[26:27], v[62:63] op_sel_hi:[1,0,1] neg_lo:[0,1,0] neg_hi:[0,1,0]
    v_pk_fma_f32 v[160:161], v[160:161], v[18:19], v[92:93] op_sel_hi:[1,0,1]
    v_pk_fma_f32 v[164:165], v[164:165], v[18:19], v[96:97] op_sel_hi:[1,0,1]
    v_pk_fma_f32 v[162:163], v[162:163], v[18:19], v[94:95] op_sel_hi:[1,0,1]
    v_pk_fma_f32 v[166:167], v[166:167], v[18:19], v[98:99] op_sel_hi:[1,0,1]
    v_max_f32 v92, 0, v160
    v_max_f32 v96, 0, v164
    v_max_f32 v93, 0, v161
    v_max_f32 v97, 0, v165
    v_max_f32 v94, 0, v162
    v_max_f32 v98, 0, v166
    v_max_f32 v95, 0, v163
    v_max_f32 v99, 0, v167
    v_pk_mul_f32 v[160:161], v[160:161], v[92:93]
    v_pk_mul_f32 v[164:165], v[164:165], v[96:97]
    v_pk_mul_f32 v[162:163], v[162:163], v[94:95]
    v_pk_mul_f32 v[166:167], v[166:167], v[98:99]
    v_cvt_pk_bf16_f32 v100, v160, v161
    v_cvt_pk_bf16_f32 v102, v164, v165
    v_cvt_pk_bf16_f32 v101, v162, v163
    v_cvt_pk_bf16_f32 v103, v166, v167
    buffer_store_dwordx4 v[100:103], v14, s[48:51], s42 offen offset:3072 sc1
    s_add_u32 s42, s42, 114688
    v_pk_fma_f32 v[92:93], v[64:65], v[28:29], v[36:37] op_sel_hi:[1,0,1] neg_lo:[0,1,0] neg_hi:[0,1,0]
    v_pk_fma_f32 v[94:95], v[66:67], v[28:29], v[38:39] op_sel_hi:[1,0,1] neg_lo:[0,1,0] neg_hi:[0,1,0]
    v_pk_fma_f32 v[168:169], v[168:169], v[20:21], v[92:93] op_sel_hi:[1,0,1]
    v_pk_fma_f32 v[170:171], v[170:171], v[20:21], v[94:95] op_sel_hi:[1,0,1]
    v_max_f32 v92, 0, v168
    v_max_f32 v93, 0, v169
    v_max_f32 v94, 0, v170
    v_max_f32 v95, 0, v171
    v_pk_mul_f32 v[168:169], v[168:169], v[92:93]
    v_pk_mul_f32 v[170:171], v[170:171], v[94:95]
    v_cvt_pk_bf16_f32 v100, v168, v169
    v_cvt_pk_bf16_f32 v101, v170, v171
    buffer_store_dwordx2 v[100:101], v14, s[48:51], s42 offen offset:8 sc1
    v_pk_fma_f32 v[92:93], v[68:69], v[28:29], v[40:41] op_sel_hi:[1,0,1] neg_lo:[0,1,0] neg_hi:[0,1,0]
    v_pk_fma_f32 v[96:97], v[72:73], v[28:29], v[44:45] op_sel_hi:[1,0,1] neg_lo:[0,1,0] neg_hi:[0,1,0]
    v_pk_fma_f32 v[94:95], v[70:71], v[28:29], v[42:43] op_sel_hi:[1,0,1] neg_lo:[0,1,0] neg_hi:[0,1,0]
    v_pk_fma_f32 v[98:99], v[74:75], v[28:29], v[46:47] op_sel_hi:[1,0,1] neg_lo:[0,1,0] neg_hi:[0,1,0]
    v_pk_fma_f32 v[172:173], v[172:173], v[20:21], v[92:93] op_sel_hi:[1,0,1]
    v_pk_fma_f32 v[176:177], v[176:177], v[20:21], v[96:97] op_sel_hi:[1,0,1]
    v_pk_fma_f32 v[174:175], v[174:175], v[20:21], v[94:95] op_sel_hi:[1,0,1]
    v_pk_fma_f32 v[178:179], v[178:179], v[20:21], v[98:99] op_sel_hi:[1,0,1]
    v_max_f32 v92, 0, v172
    v_max_f32 v96, 0, v176
    v_max_f32 v93, 0, v173
    v_max_f32 v97, 0, v177
    v_max_f32 v94, 0, v174
    v_max_f32 v98, 0, v178
    v_max_f32 v95, 0, v175
    v_max_f32 v99, 0, v179
    v_pk_mul_f32 v[172:173], v[172:173], v[92:93]
    v_pk_mul_f32 v[176:177], v[176:177], v[96:97]
    v_pk_mul_f32 v[174:175], v[174:175], v[94:95]
    v_pk_mul_f32 v[178:179], v[178:179], v[98:99]
    v_cvt_pk_bf16_f32 v104, v172, v173
    v_cvt_pk_bf16_f32 v106, v176, v177
    v_cvt_pk_bf16_f32 v105, v174, v175
    v_cvt_pk_bf16_f32 v107, v178, v179
    buffer_store_dwordx4 v[104:107], v14, s[48:51], s42 offen offset:1024 sc1
    v_pk_fma_f32 v[92:93], v[76:77], v[28:29], v[48:49] op_sel_hi:[1,0,1] neg_lo:[0,1,0] neg_hi:[0,1,0]
    v_pk_fma_f32 v[96:97], v[80:81], v[28:29], v[52:53] op_sel_hi:[1,0,1] neg_lo:[0,1,0] neg_hi:[0,1,0]
    v_pk_fma_f32 v[94:95], v[78:79], v[28:29], v[50:51] op_sel_hi:[1,0,1] neg_lo:[0,1,0] neg_hi:[0,1,0]
    v_pk_fma_f32 v[98:99], v[82:83], v[28:29], v[54:55] op_sel_hi:[1,0,1] neg_lo:[0,1,0] neg_hi:[0,1,0]
    v_pk_fma_f32 v[180:181], v[180:181], v[20:21], v[92:93] op_sel_hi:[1,0,1]
    v_pk_fma_f32 v[184:185], v[184:185], v[20:21], v[96:97] op_sel_hi:[1,0,1]
    v_pk_fma_f32 v[182:183], v[182:183], v[20:21], v[94:95] op_sel_hi:[1,0,1]
    v_pk_fma_f32 v[186:187], v[186:187], v[20:21], v[98:99] op_sel_hi:[1,0,1]
    v_max_f32 v92, 0, v180
    v_max_f32 v96, 0, v184
    v_max_f32 v93, 0, v181
    v_max_f32 v97, 0, v185
    v_max_f32 v94, 0, v182
    v_max_f32 v98, 0, v186
    v_max_f32 v95, 0, v183
    v_max_f32 v99, 0, v187
    v_pk_mul_f32 v[180:181], v[180:181], v[92:93]
    v_pk_mul_f32 v[184:185], v[184:185], v[96:97]
    v_pk_mul_f32 v[182:183], v[182:183], v[94:95]
    v_pk_mul_f32 v[186:187], v[186:187], v[98:99]
    v_cvt_pk_bf16_f32 v108, v180, v181
    v_cvt_pk_bf16_f32 v110, v184, v185
    v_cvt_pk_bf16_f32 v109, v182, v183
    v_cvt_pk_bf16_f32 v111, v186, v187
    buffer_store_dwordx4 v[108:111], v14, s[48:51], s42 offen offset:2048 sc1
    v_pk_fma_f32 v[92:93], v[84:85], v[28:29], v[56:57] op_sel_hi:[1,0,1] neg_lo:[0,1,0] neg_hi:[0,1,0]
    v_pk_fma_f32 v[96:97], v[88:89], v[28:29], v[60:61] op_sel_hi:[1,0,1] neg_lo:[0,1,0] neg_hi:[0,1,0]
    v_pk_fma_f32 v[94:95], v[86:87], v[28:29], v[58:59] op_sel_hi:[1,0,1] neg_lo:[0,1,0] neg_hi:[0,1,0]
    v_pk_fma_f32 v[98:99], v[90:91], v[28:29], v[62:63] op_sel_hi:[1,0,1] neg_lo:[0,1,0] neg_hi:[0,1,0]
    v_pk_fma_f32 v[188:189], v[188:189], v[20:21], v[92:93] op_sel_hi:[1,0,1]
    v_pk_fma_f32 v[192:193], v[192:193], v[20:21], v[96:97] op_sel_hi:[1,0,1]
    v_pk_fma_f32 v[190:191], v[190:191], v[20:21], v[94:95] op_sel_hi:[1,0,1]
    v_pk_fma_f32 v[194:195], v[194:195], v[20:21], v[98:99] op_sel_hi:[1,0,1]
    v_max_f32 v92, 0, v188
    v_max_f32 v96, 0, v192
    v_max_f32 v93, 0, v189
    v_max_f32 v97, 0, v193
    v_max_f32 v94, 0, v190
    v_max_f32 v98, 0, v194
    v_max_f32 v95, 0, v191
    v_max_f32 v99, 0, v195
    v_pk_mul_f32 v[188:189], v[188:189], v[92:93]
    v_pk_mul_f32 v[192:193], v[192:193], v[96:97]
    v_pk_mul_f32 v[190:191], v[190:191], v[94:95]
    v_pk_mul_f32 v[194:195], v[194:195], v[98:99]
    v_cvt_pk_bf16_f32 v100, v188, v189
    v_cvt_pk_bf16_f32 v102, v192, v193
    v_cvt_pk_bf16_f32 v101, v190, v191
    v_cvt_pk_bf16_f32 v103, v194, v195
    buffer_store_dwordx4 v[100:103], v14, s[48:51], s42 offen offset:3072 sc1
    s_add_u32 s42, s42, 114688
    v_pk_fma_f32 v[92:93], v[64:65], v[30:31], v[36:37] op_sel_hi:[1,0,1] neg_lo:[0,1,0] neg_hi:[0,1,0]
    v_pk_fma_f32 v[94:95], v[66:67], v[30:31], v[38:39] op_sel_hi:[1,0,1] neg_lo:[0,1,0] neg_hi:[0,1,0]
    v_pk_fma_f32 v[196:197], v[196:197], v[22:23], v[92:93] op_sel_hi:[1,0,1]
    v_pk_fma_f32 v[198:199], v[198:199], v[22:23], v[94:95] op_sel_hi:[1,0,1]
    v_max_f32 v92, 0, v196
    v_max_f32 v93, 0, v197
    v_max_f32 v94, 0, v198
    v_max_f32 v95, 0, v199
    v_pk_mul_f32 v[196:197], v[196:197], v[92:93]
    v_pk_mul_f32 v[198:199], v[198:199], v[94:95]
    v_cvt_pk_bf16_f32 v100, v196, v197
    v_cvt_pk_bf16_f32 v101, v198, v199
    buffer_store_dwordx2 v[100:101], v14, s[48:51], s42 offen offset:8 sc1
    v_pk_fma_f32 v[92:93], v[68:69], v[30:31], v[40:41] op_sel_hi:[1,0,1] neg_lo:[0,1,0] neg_hi:[0,1,0]
    v_pk_fma_f32 v[96:97], v[72:73], v[30:31], v[44:45] op_sel_hi:[1,0,1] neg_lo:[0,1,0] neg_hi:[0,1,0]
    v_pk_fma_f32 v[94:95], v[70:71], v[30:31], v[42:43] op_sel_hi:[1,0,1] neg_lo:[0,1,0] neg_hi:[0,1,0]
    v_pk_fma_f32 v[98:99], v[74:75], v[30:31], v[46:47] op_sel_hi:[1,0,1] neg_lo:[0,1,0] neg_hi:[0,1,0]
    v_pk_fma_f32 v[200:201], v[200:201], v[22:23], v[92:93] op_sel_hi:[1,0,1]
    v_pk_fma_f32 v[204:205], v[204:205], v[22:23], v[96:97] op_sel_hi:[1,0,1]
    v_pk_fma_f32 v[202:203], v[202:203], v[22:23], v[94:95] op_sel_hi:[1,0,1]
    v_pk_fma_f32 v[206:207], v[206:207], v[22:23], v[98:99] op_sel_hi:[1,0,1]
    v_max_f32 v92, 0, v200
    v_max_f32 v96, 0, v204
    v_max_f32 v93, 0, v201
    v_max_f32 v97, 0, v205
    v_max_f32 v94, 0, v202
    v_max_f32 v98, 0, v206
    v_max_f32 v95, 0, v203
    v_max_f32 v99, 0, v207
    v_pk_mul_f32 v[200:201], v[200:201], v[92:93]
    v_pk_mul_f32 v[204:205], v[204:205], v[96:97]
    v_pk_mul_f32 v[202:203], v[202:203], v[94:95]
    v_pk_mul_f32 v[206:207], v[206:207], v[98:99]
    v_cvt_pk_bf16_f32 v104, v200, v201
    v_cvt_pk_bf16_f32 v106, v204, v205
    v_cvt_pk_bf16_f32 v105, v202, v203
    v_cvt_pk_bf16_f32 v107, v206, v207
    buffer_store_dwordx4 v[104:107], v14, s[48:51], s42 offen offset:1024 sc1
    v_pk_fma_f32 v[92:93], v[76:77], v[30:31], v[48:49] op_sel_hi:[1,0,1] neg_lo:[0,1,0] neg_hi:[0,1,0]
    v_pk_fma_f32 v[96:97], v[80:81], v[30:31], v[52:53] op_sel_hi:[1,0,1] neg_lo:[0,1,0] neg_hi:[0,1,0]
    v_pk_fma_f32 v[94:95], v[78:79], v[30:31], v[50:51] op_sel_hi:[1,0,1] neg_lo:[0,1,0] neg_hi:[0,1,0]
    v_pk_fma_f32 v[98:99], v[82:83], v[30:31], v[54:55] op_sel_hi:[1,0,1] neg_lo:[0,1,0] neg_hi:[0,1,0]
    v_pk_fma_f32 v[208:209], v[208:209], v[22:23], v[92:93] op_sel_hi:[1,0,1]
    v_pk_fma_f32 v[212:213], v[212:213], v[22:23], v[96:97] op_sel_hi:[1,0,1]
    v_pk_fma_f32 v[210:211], v[210:211], v[22:23], v[94:95] op_sel_hi:[1,0,1]
    v_pk_fma_f32 v[214:215], v[214:215], v[22:23], v[98:99] op_sel_hi:[1,0,1]
    v_max_f32 v92, 0, v208
    v_max_f32 v96, 0, v212
    v_max_f32 v93, 0, v209
    v_max_f32 v97, 0, v213
    v_max_f32 v94, 0, v210
    v_max_f32 v98, 0, v214
    v_max_f32 v95, 0, v211
    v_max_f32 v99, 0, v215
    v_pk_mul_f32 v[208:209], v[208:209], v[92:93]
    v_pk_mul_f32 v[212:213], v[212:213], v[96:97]
    v_pk_mul_f32 v[210:211], v[210:211], v[94:95]
    v_pk_mul_f32 v[214:215], v[214:215], v[98:99]
    v_cvt_pk_bf16_f32 v108, v208, v209
    v_cvt_pk_bf16_f32 v110, v212, v213
    v_cvt_pk_bf16_f32 v109, v210, v211
    v_cvt_pk_bf16_f32 v111, v214, v215
    buffer_store_dwordx4 v[108:111], v14, s[48:51], s42 offen offset:2048 sc1
    v_pk_fma_f32 v[92:93], v[84:85], v[30:31], v[56:57] op_sel_hi:[1,0,1] neg_lo:[0,1,0] neg_hi:[0,1,0]
    v_pk_fma_f32 v[96:97], v[88:89], v[30:31], v[60:61] op_sel_hi:[1,0,1] neg_lo:[0,1,0] neg_hi:[0,1,0]
    v_pk_fma_f32 v[94:95], v[86:87], v[30:31], v[58:59] op_sel_hi:[1,0,1] neg_lo:[0,1,0] neg_hi:[0,1,0]
    v_pk_fma_f32 v[98:99], v[90:91], v[30:31], v[62:63] op_sel_hi:[1,0,1] neg_lo:[0,1,0] neg_hi:[0,1,0]
    v_pk_fma_f32 v[216:217], v[216:217], v[22:23], v[92:93] op_sel_hi:[1,0,1]
    v_pk_fma_f32 v[220:221], v[220:221], v[22:23], v[96:97] op_sel_hi:[1,0,1]
    v_pk_fma_f32 v[218:219], v[218:219], v[22:23], v[94:95] op_sel_hi:[1,0,1]
    v_pk_fma_f32 v[222:223], v[222:223], v[22:23], v[98:99] op_sel_hi:[1,0,1]
    v_max_f32 v92, 0, v216
    v_max_f32 v96, 0, v220
    v_max_f32 v93, 0, v217
    v_max_f32 v97, 0, v221
    v_max_f32 v94, 0, v218
    v_max_f32 v98, 0, v222
    v_max_f32 v95, 0, v219
    v_max_f32 v99, 0, v223
    v_pk_mul_f32 v[216:217], v[216:217], v[92:93]
    v_pk_mul_f32 v[220:221], v[220:221], v[96:97]
    v_pk_mul_f32 v[218:219], v[218:219], v[94:95]
    v_pk_mul_f32 v[222:223], v[222:223], v[98:99]
    v_cvt_pk_bf16_f32 v100, v216, v217
    v_cvt_pk_bf16_f32 v102, v220, v221
    v_cvt_pk_bf16_f32 v101, v218, v219
    v_cvt_pk_bf16_f32 v103, v222, v223
    buffer_store_dwordx4 v[100:103], v14, s[48:51], s42 offen offset:3072 sc1
K3_cend:
    s_waitcnt vmcnt(0)
    s_barrier
    s_cmp_lg_u32 s16, 0
    s_cbranch_scc1 K3_end
    s_add_u32 s56, s34, 0x1e00000
    s_addc_u32 s57, s35, 0
    s_mov_b32 s58, 0x10000
    s_mov_b32 s59, 0x20000
    s_lshl_b32 s41, s17, 1
    s_lshr_b32 s42, s18, 3
    s_add_u32 s41, s41, s42
    s_add_u32 s41, s41, 96
    s_lshl_b32 s41, s41, 8
    v_mov_b32 v40, 1
    v_mov_b32 v41, 0
    s_mov_b64 s[78:79], exec
    s_mov_b64 exec, 1
    buffer_atomic_add v40, v41, s[56:59], s41 offen
    s_mov_b64 exec, s[78:79]
    s_branch K3_end
K3_loader:
    s_sub_u32 s23, s16, 4
    v_lshlrev_b32 v2, 4, v1
    s_mul_i32 s24, s23, 2
    s_add_u32 s24, s24, s44
    s_mul_i32 s24, s24, 32768
    v_add_u32 v3, s24, v2
    s_add_u32 s24, s24, 32768
    v_add_u32 v4, s24, v2
    s_mov_b32 s24, 7168
    v_lshrrev_b32 v5, 3, v1
    v_mul_lo_u32 v7, v5, s24
    v_bfe_u32 v5, v1, 4, 2
    v_lshlrev_b32 v5, 1, v5
    v_and_b32 v6, 7, v1
    v_xor_b32 v5, v5, v6
    v_lshl_add_u32 v7, v5, 4, v7
    s_mul_i32 s25, s23, 114688
    s_add_u32 s24, s25, s45
    v_add_u32 v8, s24, v7
    v_add_u32 v9, 56320, v8
    s_add_u32 s24, s25, s46
    v_add_u32 v10, s24, v7
    v_add_u32 v11, 56320, v10
    s_add_u32 s24, s25, s47
    v_add_u32 v12, s24, v7
    v_add_u32 v13, 56320, v12
    s_add_u32 s24, s25, s48
    v_add_u32 v14, s24, v7
    v_add_u32 v15, 56320, v14
    s_mul_i32 s27, s23, 4096
    s_lshl_b32 s28, s23, 11
    s_add_u32 s12, s34, 0x1c00000
    s_addc_u32 s13, s35, 0
    s_mov_b32 s14, 0x100000
    s_mov_b32 s15, 0x20000
    s_add_u32 s52, s34, 0x1f00000
    s_addc_u32 s53, s35, 0
    s_mov_b32 s54, 0x40000
    s_mov_b32 s55, 0x20000
    s_add_u32 s56, s34, 0x1e00000
    s_addc_u32 s57, s35, 0
    s_mov_b32 s58, 0x10000
    s_mov_b32 s59, 0x20000
    s_sub_u32 s49, s16, 4
    s_lshl_b32 s40, s17, 7
    s_lshl_b32 s42, s49, 5
    s_add_u32 s40, s40, s42
    v_and_b32 v30, 15, v1
    v_add_u32 v30, s40, v30
    v_lshlrev_b32 v30, 7, v30
    v_lshrrev_b32 v31, 4, v1
    v_lshl_add_u32 v30, v31, 5, v30
    s_add_u32 s50, s18, 64
    s_lshl_b32 s50, s50, 8
    v_lshrrev_b32 v26, 3, v1
    s_mov_b32 s42, 7168
    v_mul_lo_u32 v26, v26, s42
    v_and_b32 v27, 7, v1
    v_lshl_add_u32 v26, v27, 4, v26
    s_mul_i32 s40, s17, 458752
    s_lshl_b32 s42, s49, 7
    s_add_u32 s40, s40, s42
    s_add_u32 s40, s40, s45
    v_add_u32 v26, s40, v26
    s_lshl_b32 s40, s18, 4
    s_add_u32 s40, s40, s17
    s_lshl_b32 s40, s40, 10
    s_lshl_b32 s42, s49, 8
    s_add_u32 s40, s40, s42
    v_lshlrev_b32 v25, 5, v27
    v_add_u32 v25, s40, v25
    s_lshl_b32 s40, s18, 14
    s_lshl_b32 s42, s49, 8
    s_add_u32 s40, s40, s42
    v_lshlrev_b32 v29, 12, v31
    v_and_b32 v28, 15, v1
    v_lshl_add_u32 v29, v28, 4, v29
    v_add_u32 v29, s40, v29
    s_mov_b32 s20, 0
    s_mov_b32 s21, 0
    s_mov_b32 s22, 0
    s_add_u32 s24, s20, s28
    s_add_u32 m0, s24, 16384
    s_nop 0
    buffer_load_dwordx4 v8, s[8:11], s22 offen offset:0  lds
    buffer_load_dwordx4 v9, s[8:11], s22 offen offset:1024  lds
    s_add_u32 m0, s24, 24576
    s_nop 0
    buffer_load_dwordx4 v10, s[8:11], s22 offen offset:0  lds
    buffer_load_dwordx4 v11, s[8:11], s22 offen offset:1024  lds
    s_add_u32 m0, s24, 32768
    s_nop 0
    buffer_load_dwordx4 v12, s[8:11], s22 offen offset:0  lds
    buffer_load_dwordx4 v13, s[8:11], s22 offen offset:1024  lds
    s_add_u32 m0, s24, 40960
    s_nop 0
    buffer_load_dwordx4 v14, s[8:11], s22 offen offset:0  lds
    buffer_load_dwordx4 v15, s[8:11], s22 offen offset:1024  lds
    s_mov_b32 s20, 49152
    s_add_u32 s22, s22, 458752
    s_add_u32 s24, s20, s28
    s_add_u32 m0, s24, 16384
    s_nop 0
    buffer_load_dwordx4 v8, s[8:11], s22 offen offset:0  lds
    buffer_load_dwordx4 v9, s[8:11], s22 offen offset:1024  lds
    s_add_u32 m0, s24, 24576
    s_nop 0
    buffer_load_dwordx4 v10, s[8:11], s22 offen offset:0  lds
    buffer_load_dwordx4 v11, s[8:11], s22 offen offset:1024  lds
    s_add_u32 m0, s24, 32768
    s_nop 0
    buffer_load_dwordx4 v12, s[8:11], s22 offen offset:0  lds
    buffer_load_dwordx4 v13, s[8:11], s22 offen offset:1024  lds
    s_add_u32 m0, s24, 40960
    s_nop 0
    buffer_load_dwordx4 v14, s[8:11], s22 offen offset:0  lds
    buffer_load_dwordx4 v15, s[8:11], s22 offen offset:1024  lds
    s_add_u32 s22, s22, 458752
    s_add_u32 s41, s17, 80
    s_lshl_b32 s41, s41, 8
    s_mov_b32 s77, 0x40000
    v_mov_b32 v205, 0
K3_g:
    buffer_load_dword v204, v205, s[56:59], s41 offen sc1
    s_waitcnt vmcnt(0)
    v_readfirstlane_b32 s78, v204
    s_nop 3
    s_cmp_ge_u32 s78, 16
    s_cbranch_scc1 K3_g_done
    s_sleep 1
    s_sub_u32 s77, s77, 1
    s_cmp_lg_u32 s77, 0
    s_cbranch_scc1 K3_g
K3_g_done:
    s_mov_b32 s20, 0
    s_add_u32 m0, s20, s27
    s_nop 0
    buffer_load_dwordx4 v3, s[4:7], s21 offen offset:0  lds
    buffer_load_dwordx4 v3, s[4:7], s21 offen offset:1024  lds
    s_add_u32 m0, m0, 2048
    s_nop 0
    buffer_load_dwordx4 v4, s[4:7], s21 offen offset:0  lds
    buffer_load_dwordx4 v4, s[4:7], s21 offen offset:1024  lds
    s_mov_b32 s20, 49152
    s_add_u32 s21, s21, 2048
    s_add_u32 m0, s20, s27
    s_nop 0
    buffer_load_dwordx4 v3, s[4:7], s21 offen offset:0  lds
    buffer_load_dwordx4 v3, s[4:7], s21 offen offset:1024  lds
    s_add_u32 m0, m0, 2048
    s_nop 0
    buffer_load_dwordx4 v4, s[4:7], s21 offen offset:0  lds
    buffer_load_dwordx4 v4, s[4:7], s21 offen offset:1024  lds
    s_add_u32 s21, s21, 2048
    s_mov_b32 s20, 98304
    s_waitcnt vmcnt(4)
    s_barrier
    s_add_u32 m0, s20, s27
    s_nop 0
    buffer_load_dwordx4 v3, s[4:7], s21 offen offset:0  lds
    buffer_load_dwordx4 v3, s[4:7], s21 offen offset:1024  lds
    s_add_u32 m0, m0, 2048
    s_nop 0
    buffer_load_dwordx4 v4, s[4:7], s21 offen offset:0  lds
    buffer_load_dwordx4 v4, s[4:7], s21 offen offset:1024  lds
    s_add_u32 s24, s20, s28
    s_add_u32 m0, s24, 16384
    s_nop 0
    buffer_load_dwordx4 v8, s[8:11], s22 offen offset:0  lds
    buffer_load_dwordx4 v9, s[8:11], s22 offen offset:1024  lds
    s_add_u32 m0, s24, 24576
    s_nop 0
    buffer_load_dwordx4 v10, s[8:11], s22 offen offset:0  lds
    buffer_load_dwordx4 v11, s[8:11], s22 offen offset:1024  lds
    s_add_u32 m0, s24, 32768
    s_nop 0
    buffer_load_dwordx4 v12, s[8:11], s22 offen offset:0  lds
    buffer_load_dwordx4 v13, s[8:11], s22 offen offset:1024  lds
    s_add_u32 m0, s24, 40960
    s_nop 0
    buffer_load_dwordx4 v14, s[8:11], s22 offen offset:0  lds
    buffer_load_dwordx4 v15, s[8:11], s22 offen offset:1024  lds
    s_add_u32 s21, s21, 2048
    s_add_u32 s22, s22, 458752
    s_add_u32 s20, s20, 49152
    s_cmp_eq_u32 s20, 147456
    s_cselect_b32 s20, 0, s20
    s_mov_b32 s42, 0
    buffer_load_dwordx4 v[160:163], v26, s[8:11], s42 offen
    s_add_u32 s42, s42, 57344
    buffer_load_dwordx4 v[164:167], v26, s[8:11], s42 offen
    s_add_u32 s42, s42, 57344
    buffer_load_dwordx4 v[168:171], v26, s[8:11], s42 offen
    s_add_u32 s42, s42, 57344
    buffer_load_dwordx4 v[172:175], v26, s[8:11], s42 offen
    s_add_u32 s42, s42, 57344
    buffer_load_dwordx4 v[176:179], v26, s[8:11], s42 offen
    s_add_u32 s42, s42, 57344
    buffer_load_dwordx4 v[180:183], v26, s[8:11], s42 offen
    s_add_u32 s42, s42, 57344
    buffer_load_dwordx4 v[184:187], v26, s[8:11], s42 offen
    s_add_u32 s42, s42, 57344
    buffer_load_dwordx4 v[188:191], v26, s[8:11], s42 offen
    s_mov_b32 s19, 13
K3_lloop:
    s_waitcnt vmcnt(12)
    s_barrier
    s_add_u32 m0, s20, s27
    s_nop 0
    buffer_load_dwordx4 v3, s[4:7], s21 offen offset:0  lds
    buffer_load_dwordx4 v3, s[4:7], s21 offen offset:1024  lds
    s_add_u32 m0, m0, 2048
    s_nop 0
    buffer_load_dwordx4 v4, s[4:7], s21 offen offset:0  lds
    buffer_load_dwordx4 v4, s[4:7], s21 offen offset:1024  lds
    s_add_u32 s24, s20, s28
    s_add_u32 m0, s24, 16384
    s_nop 0
    buffer_load_dwordx4 v8, s[8:11], s22 offen offset:0  lds
    buffer_load_dwordx4 v9, s[8:11], s22 offen offset:1024  lds
    s_add_u32 m0, s24, 24576
    s_nop 0
    buffer_load_dwordx4 v10, s[8:11], s22 offen offset:0  lds
    buffer_load_dwordx4 v11, s[8:11], s22 offen offset:1024  lds
    s_add_u32 m0, s24, 32768
    s_nop 0
    buffer_load_dwordx4 v12, s[8:11], s22 offen offset:0  lds
    buffer_load_dwordx4 v13, s[8:11], s22 offen offset:1024  lds
    s_add_u32 m0, s24, 40960
    s_nop 0
    buffer_load_dwordx4 v14, s[8:11], s22 offen offset:0  lds
    buffer_load_dwordx4 v15, s[8:11], s22 offen offset:1024  lds
    s_add_u32 s21, s21, 2048
    s_add_u32 s22, s22, 458752
    s_add_u32 s20, s20, 49152
    s_cmp_eq_u32 s20, 147456
    s_cselect_b32 s20, 0, s20
    s_cmp_eq_u32 s19, 12
    s_cbranch_scc1 K3_hook2
    s_cmp_eq_u32 s19, 9
    s_cbranch_scc1 K3_hook5
    s_cmp_eq_u32 s19, 4
    s_cbranch_scc1 K3_hook10
    s_cmp_eq_u32 s19, 2
    s_cbranch_scc1 K3_hook12
K3_hookret:
    s_sub_u32 s19, s19, 1
    s_cmp_lg_u32 s19, 0
    s_cbranch_scc1 K3_lloop
    s_branch K3_lafter
K3_hook2:
    v_mov_b32 v192, 0
    v_mov_b32 v193, 0
    v_mov_b32 v194, 0
    v_mov_b32 v195, 0
    v_mov_b32 v196, 0
    v_mov_b32 v197, 0
    v_mov_b32 v198, 0
    v_mov_b32 v199, 0
    v_lshlrev_b32 v200, 16, v160
    v_and_b32 v201, 0xffff0000, v160
    v_pk_add_f32 v[192:193], v[192:193], v[200:201]
    v_lshlrev_b32 v202, 16, v161
    v_and_b32 v203, 0xffff0000, v161
    v_pk_add_f32 v[194:195], v[194:195], v[202:203]
    v_lshlrev_b32 v200, 16, v162
    v_and_b32 v201, 0xffff0000, v162
    v_pk_add_f32 v[196:197], v[196:197], v[200:201]
    v_lshlrev_b32 v202, 16, v163
    v_and_b32 v203, 0xffff0000, v163
    v_pk_add_f32 v[198:199], v[198:199], v[202:203]
    v_lshlrev_b32 v200, 16, v164
    v_and_b32 v201, 0xffff0000, v164
    v_pk_add_f32 v[192:193], v[192:193], v[200:201]
    v_lshlrev_b32 v202, 16, v165
    v_and_b32 v203, 0xffff0000, v165
    v_pk_add_f32 v[194:195], v[194:195], v[202:203]
    v_lshlrev_b32 v200, 16, v166
    v_and_b32 v201, 0xffff0000, v166
    v_pk_add_f32 v[196:197], v[196:197], v[200:201]
    v_lshlrev_b32 v202, 16, v167
    v_and_b32 v203, 0xffff0000, v167
    v_pk_add_f32 v[198:199], v[198:199], v[202:203]
    v_lshlrev_b32 v200, 16, v168
    v_and_b32 v201, 0xffff0000, v168
    v_pk_add_f32 v[192:193], v[192:193], v[200:201]
    v_lshlrev_b32 v202, 16, v169
    v_and_b32 v203, 0xffff0000, v169
    v_pk_add_f32 v[194:195], v[194:195], v[202:203]
    v_lshlrev_b32 v200, 16, v170
    v_and_b32 v201, 0xffff0000, v170
    v_pk_add_f32 v[196:197], v[196:197], v[200:201]
    v_lshlrev_b32 v202, 16, v171
    v_and_b32 v203, 0xffff0000, v171
    v_pk_add_f32 v[198:199], v[198:199], v[202:203]
    v_lshlrev_b32 v200, 16, v172
    v_and_b32 v201, 0xffff0000, v172
    v_pk_add_f32 v[192:193], v[192:193], v[200:201]
    v_lshlrev_b32 v202, 16, v173
    v_and_b32 v203, 0xffff0000, v173
    v_pk_add_f32 v[194:195], v[194:195], v[202:203]
    v_lshlrev_b32 v200, 16, v174
    v_and_b32 v201, 0xffff0000, v174
    v_pk_add_f32 v[196:197], v[196:197], v[200:201]
    v_lshlrev_b32 v202, 16, v175
    v_and_b32 v203, 0xffff0000, v175
    v_pk_add_f32 v[198:199], v[198:199], v[202:203]
    v_lshlrev_b32 v200, 16, v176
    v_and_b32 v201, 0xffff0000, v176
    v_pk_add_f32 v[192:193], v[192:193], v[200:201]
    v_lshlrev_b32 v202, 16, v177
    v_and_b32 v203, 0xffff0000, v177
    v_pk_add_f32 v[194:195], v[194:195], v[202:203]
    v_lshlrev_b32 v200, 16, v178
    v_and_b32 v201, 0xffff0000, v178
    v_pk_add_f32 v[196:197], v[196:197], v[200:201]
    v_lshlrev_b32 v202, 16, v179
    v_and_b32 v203, 0xffff0000, v179
    v_pk_add_f32 v[198:199], v[198:199], v[202:203]
    v_lshlrev_b32 v200, 16, v180
    v_and_b32 v201, 0xffff0000, v180
    v_pk_add_f32 v[192:193], v[192:193], v[200:201]
    v_lshlrev_b32 v202, 16, v181
    v_and_b32 v203, 0xffff0000, v181
    v_pk_add_f32 v[194:195], v[194:195], v[202:203]
    v_lshlrev_b32 v200, 16, v182
    v_and_b32 v201, 0xffff0000, v182
    v_pk_add_f32 v[196:197], v[196:197], v[200:201]
    v_lshlrev_b32 v202, 16, v183
    v_and_b32 v203, 0xffff0000, v183
    v_pk_add_f32 v[198:199], v[198:199], v[202:203]
    v_lshlrev_b32 v200, 16, v184
    v_and_b32 v201, 0xffff0000, v184
    v_pk_add_f32 v[192:193], v[192:193], v[200:201]
    v_lshlrev_b32 v202, 16, v185
    v_and_b32 v203, 0xffff0000, v185
    v_pk_add_f32 v[194:195], v[194:195], v[202:203]
    v_lshlrev_b32 v200, 16, v186
    v_and_b32 v201, 0xffff0000, v186
    v_pk_add_f32 v[196:197], v[196:197], v[200:201]
    v_lshlrev_b32 v202, 16, v187
    v_and_b32 v203, 0xffff0000, v187
    v_pk_add_f32 v[198:199], v[198:199], v[202:203]
    v_lshlrev_b32 v200, 16, v188
    v_and_b32 v201, 0xffff0000, v188
    v_pk_add_f32 v[192:193], v[192:193], v[200:201]
    v_lshlrev_b32 v202, 16, v189
    v_and_b32 v203, 0xffff0000, v189
    v_pk_add_f32 v[194:195], v[194:195], v[202:203]
    v_lshlrev_b32 v200, 16, v190
    v_and_b32 v201, 0xffff0000, v190
    v_pk_add_f32 v[196:197], v[196:197], v[200:201]
    v_lshlrev_b32 v202, 16, v191
    v_and_b32 v203, 0xffff0000, v191
    v_pk_add_f32 v[198:199], v[198:199], v[202:203]
    v_add_f32_dpp v192, v192, v192 row_ror:8 row_mask:0xf bank_mask:0xf
    v_add_f32_dpp v193, v193, v193 row_ror:8 row_mask:0xf bank_mask:0xf
    v_add_f32_dpp v194, v194, v194 row_ror:8 row_mask:0xf bank_mask:0xf
    v_add_f32_dpp v195, v195, v195 row_ror:8 row_mask:0xf bank_mask:0xf
    v_add_f32_dpp v196, v196, v196 row_ror:8 row_mask:0xf bank_mask:0xf
    v_add_f32_dpp v197, v197, v197 row_ror:8 row_mask:0xf bank_mask:0xf
    v_add_f32_dpp v198, v198, v198 row_ror:8 row_mask:0xf bank_mask:0xf
    v_add_f32_dpp v199, v199, v199 row_ror:8 row_mask:0xf bank_mask:0xf
    v_permlane32_swap_b32 v192, v193
    v_permlane32_swap_b32 v194, v195
    v_add_f32 v192, v192, v193
    v_add_f32 v194, v194, v195
    s_nop 1
    v_permlane16_swap_b32 v192, v194
    v_add_f32 v192, v192, v194
    v_mov_b32 v194, v192
    s_nop 1
    v_permlane16_swap_b32 v192, v194
    v_mov_b32 v193, v192
    v_mov_b32 v195, v194
    s_nop 0
    v_permlane32_swap_b32 v192, v193
    v_permlane32_swap_b32 v194, v195
    v_permlane32_swap_b32 v196, v197
    v_permlane32_swap_b32 v198, v199
    v_add_f32 v196, v196, v197
    v_add_f32 v198, v198, v199
    s_nop 1
    v_permlane16_swap_b32 v196, v198
    v_add_f32 v196, v196, v198
    v_mov_b32 v198, v196
    s_nop 1
    v_permlane16_swap_b32 v196, v198
    v_mov_b32 v197, v196
    v_mov_b32 v199, v198
    s_nop 0
    v_permlane32_swap_b32 v196, v197
    v_permlane32_swap_b32 v198, v199
    s_mov_b64 s[78:79], exec
    s_mov_b64 exec, 0xff
    buffer_store_dwordx4 v[192:195], v25, s[52:55], 0 offen sc1
    buffer_store_dwordx4 v[196:199], v25, s[52:55], 0 offen offset:16 sc1
    s_mov_b64 exec, s[78:79]
    s_branch K3_hookret
K3_hook5:
    s_cmp_lg_u32 s16, 4
    s_cbranch_scc1 K3_hookret
    v_mov_b32 v204, 1
    v_mov_b32 v205, 0
    s_mov_b64 s[78:79], exec
    s_mov_b64 exec, 1
    buffer_atomic_add v204, v205, s[56:59], s50 offen
    s_mov_b64 exec, s[78:79]
    s_branch K3_hookret
K3_hook10:
    v_mov_b32 v207, 0
    buffer_load_dword v206, v207, s[56:59], s50 offen sc1
    s_branch K3_hookret
K3_hook12:
    v_readfirstlane_b32 s78, v206
    s_nop 3
    s_cmp_ge_u32 s78, 16
    s_cbranch_scc1 K3_hookret
    s_mov_b32 s77, 0x40000
    v_mov_b32 v207, 0
K3_sp:
    buffer_load_dword v206, v207, s[56:59], s50 offen sc1
    s_waitcnt vmcnt(0)
    v_readfirstlane_b32 s78, v206
    s_nop 3
    s_cmp_ge_u32 s78, 16
    s_cbranch_scc1 K3_sp_done
    s_sleep 1
    s_sub_u32 s77, s77, 1
    s_cmp_lg_u32 s77, 0
    s_cbranch_scc1 K3_sp
K3_sp_done:
    s_branch K3_hookret
K3_lafter:
    buffer_load_dwordx4 v[64:67], v30, s[12:15], 0 offen offset:0
    buffer_load_dwordx4 v[68:71], v30, s[12:15], 0 offen offset:16
    buffer_load_dwordx4 v[72:75], v30, s[12:15], 0 offen offset:2048
    buffer_load_dwordx4 v[76:79], v30, s[12:15], 0 offen offset:2064
    buffer_load_dwordx4 v[96:99], v29, s[52:55], 0 offen offset:0
    buffer_load_dwordx4 v[100:103], v29, s[52:55], 0 offen offset:1024
    buffer_load_dwordx4 v[104:107], v29, s[52:55], 0 offen offset:2048
    buffer_load_dwordx4 v[108:111], v29, s[52:55], 0 offen offset:3072
    s_waitcnt vmcnt(20)
    s_barrier
    s_waitcnt vmcnt(8)
    s_barrier
    s_waitcnt vmcnt(0)
    v_add_f32 v40, v64, v66
    v_add_f32 v40, v40, v68
    v_add_f32 v40, v40, v70
    v_mov_b32 v42, v40
    s_nop 1
    v_permlane32_swap_b32 v40, v42
    v_add_f32 v40, v40, v42
    v_mov_b32 v42, v40
    s_nop 1
    v_permlane16_swap_b32 v40, v42
    v_add_f32 v40, v40, v42
    v_mul_f32 v40, 0x3d800000, v40
    v_mov_b32 v41, 0
    v_sub_f32 v42, v64, v40
    v_mul_f32 v42, v42, v42
    v_fmac_f32 v41, 0x42800000, v42
    v_add_f32 v41, v41, v65
    v_sub_f32 v42, v66, v40
    v_mul_f32 v42, v42, v42
    v_fmac_f32 v41, 0x42800000, v42
    v_add_f32 v41, v41, v67
    v_sub_f32 v42, v68, v40
    v_mul_f32 v42, v42, v42
    v_fmac_f32 v41, 0x42800000, v42
    v_add_f32 v41, v41, v69
    v_sub_f32 v42, v70, v40
    v_mul_f32 v42, v42, v42
    v_fmac_f32 v41, 0x42800000, v42
    v_add_f32 v41, v41, v71
    v_mov_b32 v42, v41
    s_nop 1
    v_permlane32_swap_b32 v41, v42
    v_add_f32 v41, v41, v42
    v_mov_b32 v42, v41
    s_nop 1
    v_permlane16_swap_b32 v41, v42
    v_add_f32 v41, v41, v42
    v_mul_f32 v41, 0x3a800000, v41
    v_cvt_pk_bf16_f32 v40, v40, v40
    v_lshlrev_b32 v40, 16, v40
    v_cvt_pk_bf16_f32 v41, v41, v41
    v_lshlrev_b32 v41, 16, v41
    v_add_f32 v41, 0x3727c5ac, v41
    v_cvt_pk_bf16_f32 v41, v41, v41
    v_lshlrev_b32 v41, 16, v41
    v_sqrt_f32 v41, v41
    s_nop 0
    v_cvt_pk_bf16_f32 v41, v41, v41
    v_lshlrev_b32 v41, 16, v41
    v_rcp_f32 v50, v41
    s_nop 0
    v_mul_f32 v51, v50, v40
    v_add_f32 v44, v72, v74
    v_add_f32 v44, v44, v76
    v_add_f32 v44, v44, v78
    v_mov_b32 v46, v44
    s_nop 1
    v_permlane32_swap_b32 v44, v46
    v_add_f32 v44, v44, v46
    v_mov_b32 v46, v44
    s_nop 1
    v_permlane16_swap_b32 v44, v46
    v_add_f32 v44, v44, v46
    v_mul_f32 v44, 0x3d800000, v44
    v_mov_b32 v45, 0
    v_sub_f32 v46, v72, v44
    v_mul_f32 v46, v46, v46
    v_fmac_f32 v45, 0x42800000, v46
    v_add_f32 v45, v45, v73
    v_sub_f32 v46, v74, v44
    v_mul_f32 v46, v46, v46
    v_fmac_f32 v45, 0x42800000, v46
    v_add_f32 v45, v45, v75
    v_sub_f32 v46, v76, v44
    v_mul_f32 v46, v46, v46
    v_fmac_f32 v45, 0x42800000, v46
    v_add_f32 v45, v45, v77
    v_sub_f32 v46, v78, v44
    v_mul_f32 v46, v46, v46
    v_fmac_f32 v45, 0x42800000, v46
    v_add_f32 v45, v45, v79
    v_mov_b32 v46, v45
    s_nop 1
    v_permlane32_swap_b32 v45, v46
    v_add_f32 v45, v45, v46
    v_mov_b32 v46, v45
    s_nop 1
    v_permlane16_swap_b32 v45, v46
    v_add_f32 v45, v45, v46
    v_mul_f32 v45, 0x3a800000, v45
    v_cvt_pk_bf16_f32 v44, v44, v44
    v_lshlrev_b32 v44, 16, v44
    v_cvt_pk_bf16_f32 v45, v45, v45
    v_lshlrev_b32 v45, 16, v45
    v_add_f32 v45, 0x3727c5ac, v45
    v_cvt_pk_bf16_f32 v45, v45, v45
    v_lshlrev_b32 v45, 16, v45
    v_sqrt_f32 v45, v45
    s_nop 0
    v_cvt_pk_bf16_f32 v45, v45, v45
    v_lshlrev_b32 v45, 16, v45
    v_rcp_f32 v52, v45
    s_nop 0
    v_mul_f32 v53, v52, v44
    v_pk_add_f32 v[96:97], v[96:97], v[104:105]
    v_pk_add_f32 v[98:99], v[98:99], v[106:107]
    v_pk_add_f32 v[100:101], v[100:101], v[108:109]
    v_pk_add_f32 v[102:103], v[102:103], v[110:111]
    v_pk_add_f32 v[96:97], v[96:97], v[100:101]
    v_pk_add_f32 v[98:99], v[98:99], v[102:103]
    s_nop 0
    v_permlane32_swap_b32 v96, v97
    v_permlane32_swap_b32 v98, v99
    v_add_f32 v96, v96, v97
    v_add_f32 v98, v98, v99
    s_nop 1
    v_permlane16_swap_b32 v96, v98
    v_add_f32 v96, v96, v98
    v_mov_b32 v98, v96
    s_nop 1
    v_permlane16_swap_b32 v96, v98
    v_mov_b32 v97, v96
    v_mov_b32 v99, v98
    s_nop 0
    v_permlane32_swap_b32 v96, v97
    v_permlane32_swap_b32 v98, v99
    v_and_b32 v28, 15, v1
    v_lshlrev_b32 v28, 4, v28
    s_lshl_b32 s41, s49, 8
    s_add_u32 s41, s41, 148480
    v_add_u32 v28, s41, v28
    ds_write_b128 v28, v[96:99]
    v_and_b32 v30, 15, v1
    v_lshlrev_b32 v30, 3, v30
    s_lshl_b32 s41, s49, 8
    s_add_u32 s41, s41, 147456
    v_add_u32 v30, s41, v30
    ds_write_b64 v30, v[50:51]
    ds_write_b64 v30, v[52:53] offset:128
    s_waitcnt lgkmcnt(0)
    s_barrier
K3_end:
    s_load_dwordx2 s[34:35], s[0:1], 88
    s_load_dwordx2 s[32:33], s[0:1], 56
    s_load_dwordx2 s[36:37], s[0:1], 64
    s_load_dwordx2 s[62:63], s[0:1], 72
    s_lshr_b32 s41, s2, 3
    s_and_b32 s30, s2, 1
    s_bfe_u32 s42, s2, 0x10001
    s_lshl_b32 s42, s42, 3
    s_and_b32 s43, s41, 7
    s_add_u32 s17, s42, s43
    s_bfe_u32 s42, s2, 0x10002
    s_lshl_b32 s42, s42, 2
    s_lshr_b32 s43, s41, 3
    s_add_u32 s18, s42, s43
    s_lshl_b32 s44, s17, 3
    s_lshl_b32 s45, s18, 8
    s_mul_i32 s46, s30, 57344
    s_mul_i32 s47, s30, 3670016
    s_add_u32 s48, s45, 128
    s_waitcnt lgkmcnt(0)
    s_add_u32 s4, s34, 0x2000000
    s_addc_u32 s5, s35, 0
    s_mov_b32 s6, 0xe00000
    s_mov_b32 s7, 0x20000
    s_mov_b32 s8, s32
    s_mov_b32 s9, s33
    s_mov_b32 s10, 0x700000
    s_mov_b32 s11, 0x20000
    s_cmp_ge_u32 s16, 4
    s_cbranch_scc1 K4_loader
    s_lshr_b32 s38, s16, 1
    s_and_b32 s39, s16, 1
    s_mul_i32 s25, s38, 8192
    v_lshlrev_b32 v2, 4, v1
    v_add_u32 v2, s25, v2
    v_bfe_u32 v9, v1, 1, 1
    v_bfe_u32 v10, v1, 3, 2
    v_lshlrev_b32 v10, 1, v10
    v_xor_b32 v9, v9, v10
    v_lshrrev_b32 v10, 2, v1
    v_lshlrev_b32 v3, 7, v10
    v_lshl_add_u32 v3, v9, 4, v3
    v_and_b32 v10, 1, v1
    v_lshl_add_u32 v3, v10, 3, v3
    s_lshl_b32 s25, s39, 13
    v_add_u32 v3, s25, v3
    v_xor_b32 v4, 32, v3
    v_xor_b32 v5, 64, v3
    v_xor_b32 v6, 96, v3
    s_mov_b32 s52, s62
    s_mov_b32 s53, s63
    s_mov_b32 s54, 0x400000
    s_mov_b32 s55, 0x20000
    s_mov_b32 s56, s36
    s_mov_b32 s57, s37
    s_mov_b32 s58, 0x800
    s_mov_b32 s59, 0x20000
    s_add_u32 s48, s34, 0x1800000
    s_addc_u32 s49, s35, 0
    s_mov_b32 s50, 0x400000
    s_mov_b32 s51, 0x20000
    s_lshl_b32 s31, s18, 2
    s_lshl_b32 s41, s39, 1
    s_add_u32 s31, s31, s41
    s_add_u32 s31, s31, s30
    s_lshl_b32 s40, s38, 2
    s_add_u32 s40, s40, s44
    s_lshl_b32 s40, s40, 5
    s_add_u32 s40, s40, s31
    s_lshl_b32 s40, s40, 10
    v_lshlrev_b32 v14, 4, v1
    v_add_u32 v14, s40, v14
    s_lshl_b32 s40, s31, 5
    v_lshrrev_b32 v12, 4, v1
    v_lshlrev_b32 v12, 2, v12
    v_add_u32 v12, s40, v12
    v_lshlrev_b32 v12, 1, v12
    s_lshl_b32 s40, s17, 7
    s_lshl_b32 s42, s38, 6
    s_add_u32 s40, s40, s42
    v_and_b32 v9, 15, v1
    v_add_u32 v9, s40, v9
    v_lshlrev_b32 v9, 11, v9
    v_bfe_u32 v10, v1, 4, 1
    v_lshl_add_u32 v9, v10, 5, v9
    v_lshrrev_b32 v10, 5, v1
    v_lshl_add_u32 v9, v10, 4, v9
    s_lshl_b32 s41, s31, 6
    v_add_u32 v9, s41, v9
    s_mov_b32 s26, 0
    s_mov_b32 s27, 0xfffe8000
    s_mov_b32 s28, 32768
    s_mov_b32 s19, 26
    s_barrier
    ds_read_b128 v[16:19], v2 offset:0
    ds_read_b64_tr_b16 v[32:33], v3 offset:16384
    ds_read_b64_tr_b16 v[34:35], v3 offset:18432
    ds_read_b128 v[20:23], v2 offset:2048
    ds_read_b128 v[24:27], v2 offset:4096
    ds_read_b128 v[28:31], v2 offset:6144
    ds_read_b64_tr_b16 v[36:37], v4 offset:16384
    ds_read_b64_tr_b16 v[38:39], v4 offset:18432
    ds_read_b64_tr_b16 v[40:41], v5 offset:16384
    ds_read_b64_tr_b16 v[42:43], v5 offset:18432
    ds_read_b64_tr_b16 v[44:45], v6 offset:16384
    ds_read_b64_tr_b16 v[46:47], v6 offset:18432
    s_mov_b32 s42, 0
    buffer_load_dwordx4 v[192:195], v14, s[48:51], s42 offen
    s_add_u32 s42, s42, 32768
    buffer_load_dwordx4 v[196:199], v14, s[48:51], s42 offen
    s_add_u32 s42, s42, 32768
    buffer_load_dwordx4 v[200:203], v14, s[48:51], s42 offen
    s_add_u32 s42, s42, 32768
    buffer_load_dwordx4 v[204:207], v14, s[48:51], s42 offen
    buffer_load_dwordx2 v[208:209], v12, s[56:59], 0 offen offset:0
    buffer_load_dwordx2 v[210:211], v12, s[56:59], 0 offen offset:32
    s_waitcnt lgkmcnt(9)
    v_mfma_f32_16x16x32_bf16 v[112:115], v[32:35], v[16:19], 0
    ds_read_b128 v[48:51], v2 offset:1024
    s_waitcnt lgkmcnt(9)
    v_mfma_f32_16x16x32_bf16 v[128:131], v[32:35], v[20:23], 0
    ds_read_b64_tr_b16 v[64:65], v3 offset:20480
    s_waitcnt lgkmcnt(9)
    v_mfma_f32_16x16x32_bf16 v[144:147], v[32:35], v[24:27], 0
    ds_read_b64_tr_b16 v[66:67], v3 offset:22528
    s_waitcnt lgkmcnt(9)
    v_mfma_f32_16x16x32_bf16 v[160:163], v[32:35], v[28:31], 0
    ds_read_b128 v[52:55], v2 offset:3072
    s_waitcnt lgkmcnt(8)
    v_mfma_f32_16x16x32_bf16 v[116:119], v[36:39], v[16:19], 0
    ds_read_b128 v[56:59], v2 offset:5120
    v_mfma_f32_16x16x32_bf16 v[132:135], v[36:39], v[20:23], 0
    ds_read_b128 v[60:63], v2 offset:7168
    v_mfma_f32_16x16x32_bf16 v[148:151], v[36:39], v[24:27], 0
    ds_read_b64_tr_b16 v[68:69], v4 offset:20480
    v_mfma_f32_16x16x32_bf16 v[164:167], v[36:39], v[28:31], 0
    ds_read_b64_tr_b16 v[70:71], v4 offset:22528
    s_waitcnt lgkmcnt(10)
    v_mfma_f32_16x16x32_bf16 v[120:123], v[40:43], v[16:19], 0
    ds_read_b64_tr_b16 v[72:73], v5 offset:20480
    v_mfma_f32_16x16x32_bf16 v[136:139], v[40:43], v[20:23], 0
    ds_read_b64_tr_b16 v[74:75], v5 offset:22528
    v_mfma_f32_16x16x32_bf16 v[152:155], v[40:43], v[24:27], 0
    ds_read_b64_tr_b16 v[76:77], v6 offset:20480
    v_mfma_f32_16x16x32_bf16 v[168:171], v[40:43], v[28:31], 0
    ds_read_b64_tr_b16 v[78:79], v6 offset:22528
    s_add_u32 s26, s26, 32768
    s_cmp_eq_u32 s26, 131072
    s_cselect_b32 s23, s27, s28
    s_cselect_b32 s26, 0, s26
    v_add_u32 v2, s23, v2
    v_add_u32 v3, s23, v3
    v_add_u32 v4, s23, v4
    v_add_u32 v5, s23, v5
    v_add_u32 v6, s23, v6
    s_waitcnt lgkmcnt(12)
    v_mfma_f32_16x16x32_bf16 v[124:127], v[44:47], v[16:19], 0
    v_mfma_f32_16x16x32_bf16 v[140:143], v[44:47], v[20:23], 0
    v_mfma_f32_16x16x32_bf16 v[156:159], v[44:47], v[24:27], 0
    v_mfma_f32_16x16x32_bf16 v[172:175], v[44:47], v[28:31], 0
    s_waitcnt lgkmcnt(0)
    s_barrier
    v_mfma_f32_16x16x32_bf16 v[112:115], v[64:67], v[48:51], v[112:115]
    ds_read_b128 v[16:19], v2 offset:0
    v_mfma_f32_16x16x32_bf16 v[128:131], v[64:67], v[52:55], v[128:131]
    ds_read_b64_tr_b16 v[32:33], v3 offset:16384
    v_mfma_f32_16x16x32_bf16 v[144:147], v[64:67], v[56:59], v[144:147]
    ds_read_b64_tr_b16 v[34:35], v3 offset:18432
    v_mfma_f32_16x16x32_bf16 v[160:163], v[64:67], v[60:63], v[160:163]
    ds_read_b128 v[20:23], v2 offset:2048
    v_mfma_f32_16x16x32_bf16 v[116:119], v[68:71], v[48:51], v[116:119]
    ds_read_b128 v[24:27], v2 offset:4096
    v_mfma_f32_16x16x32_bf16 v[132:135], v[68:71], v[52:55], v[132:135]
    ds_read_b128 v[28:31], v2 offset:6144
    v_mfma_f32_16x16x32_bf16 v[148:151], v[68:71], v[56:59], v[148:151]
    ds_read_b64_tr_b16 v[36:37], v4 offset:16384
    v_mfma_f32_16x16x32_bf16 v[164:167], v[68:71], v[60:63], v[164:167]
    ds_read_b64_tr_b16 v[38:39], v4 offset:18432
    v_mfma_f32_16x16x32_bf16 v[120:123], v[72:75], v[48:51], v[120:123]
    ds_read_b64_tr_b16 v[40:41], v5 offset:16384
    v_mfma_f32_16x16x32_bf16 v[136:139], v[72:75], v[52:55], v[136:139]
    ds_read_b64_tr_b16 v[42:43], v5 offset:18432
    v_mfma_f32_16x16x32_bf16 v[152:155], v[72:75], v[56:59], v[152:155]
    ds_read_b64_tr_b16 v[44:45], v6 offset:16384
    v_mfma_f32_16x16x32_bf16 v[168:171], v[72:75], v[60:63], v[168:171]
    ds_read_b64_tr_b16 v[46:47], v6 offset:18432
    v_mfma_f32_16x16x32_bf16 v[124:127], v[76:79], v[48:51], v[124:127]
    v_mfma_f32_16x16x32_bf16 v[140:143], v[76:79], v[52:55], v[140:143]
    v_mfma_f32_16x16x32_bf16 v[156:159], v[76:79], v[56:59], v[156:159]
    v_mfma_f32_16x16x32_bf16 v[172:175], v[76:79], v[60:63], v[172:175]
K4_cloop:
    s_waitcnt lgkmcnt(9)
    v_mfma_f32_16x16x32_bf16 v[112:115], v[32:35], v[16:19], v[112:115]
    ds_read_b128 v[48:51], v2 offset:1024
    s_waitcnt lgkmcnt(9)
    v_mfma_f32_16x16x32_bf16 v[128:131], v[32:35], v[20:23], v[128:131]
    ds_read_b64_tr_b16 v[64:65], v3 offset:20480
    s_waitcnt lgkmcnt(9)
    v_mfma_f32_16x16x32_bf16 v[144:147], v[32:35], v[24:27], v[144:147]
    ds_read_b64_tr_b16 v[66:67], v3 offset:22528
    s_waitcnt lgkmcnt(9)
    v_mfma_f32_16x16x32_bf16 v[160:163], v[32:35], v[28:31], v[160:163]
    ds_read_b128 v[52:55], v2 offset:3072
    s_waitcnt lgkmcnt(8)
    v_mfma_f32_16x16x32_bf16 v[116:119], v[36:39], v[16:19], v[116:119]
    ds_read_b128 v[56:59], v2 offset:5120
    v_mfma_f32_16x16x32_bf16 v[132:135], v[36:39], v[20:23], v[132:135]
    ds_read_b128 v[60:63], v2 offset:7168
    v_mfma_f32_16x16x32_bf16 v[148:151], v[36:39], v[24:27], v[148:151]
    ds_read_b64_tr_b16 v[68:69], v4 offset:20480
    v_mfma_f32_16x16x32_bf16 v[164:167], v[36:39], v[28:31], v[164:167]
    ds_read_b64_tr_b16 v[70:71], v4 offset:22528
    s_waitcnt lgkmcnt(10)
    v_mfma_f32_16x16x32_bf16 v[120:123], v[40:43], v[16:19], v[120:123]
    ds_read_b64_tr_b16 v[72:73], v5 offset:20480
    v_mfma_f32_16x16x32_bf16 v[136:139], v[40:43], v[20:23], v[136:139]
    ds_read_b64_tr_b16 v[74:75], v5 offset:22528
    v_mfma_f32_16x16x32_bf16 v[152:155], v[40:43], v[24:27], v[152:155]
    ds_read_b64_tr_b16 v[76:77], v6 offset:20480
    v_mfma_f32_16x16x32_bf16 v[168:171], v[40:43], v[28:31], v[168:171]
    ds_read_b64_tr_b16 v[78:79], v6 offset:22528
    s_add_u32 s26, s26, 32768
    s_cmp_eq_u32 s26, 131072
    s_cselect_b32 s23, s27, s28
    s_cselect_b32 s26, 0, s26
    v_add_u32 v2, s23, v2
    v_add_u32 v3, s23, v3
    v_add_u32 v4, s23, v4
    v_add_u32 v5, s23, v5
    v_add_u32 v6, s23, v6
    s_waitcnt lgkmcnt(12)
    v_mfma_f32_16x16x32_bf16 v[124:127], v[44:47], v[16:19], v[124:127]
    v_mfma_f32_16x16x32_bf16 v[140:143], v[44:47], v[20:23], v[140:143]
    v_mfma_f32_16x16x32_bf16 v[156:159], v[44:47], v[24:27], v[156:159]
    v_mfma_f32_16x16x32_bf16 v[172:175], v[44:47], v[28:31], v[172:175]
    s_sub_u32 s19, s19, 1
    s_waitcnt lgkmcnt(0)
    s_barrier
    v_mfma_f32_16x16x32_bf16 v[112:115], v[64:67], v[48:51], v[112:115]
    ds_read_b128 v[16:19], v2 offset:0
    v_mfma_f32_16x16x32_bf16 v[128:131], v[64:67], v[52:55], v[128:131]
    ds_read_b64_tr_b16 v[32:33], v3 offset:16384
    v_mfma_f32_16x16x32_bf16 v[144:147], v[64:67], v[56:59], v[144:147]
    ds_read_b64_tr_b16 v[34:35], v3 offset:18432
    v_mfma_f32_16x16x32_bf16 v[160:163], v[64:67], v[60:63], v[160:163]
    ds_read_b128 v[20:23], v2 offset:2048
    v_mfma_f32_16x16x32_bf16 v[116:119], v[68:71], v[48:51], v[116:119]
    ds_read_b128 v[24:27], v2 offset:4096
    v_mfma_f32_16x16x32_bf16 v[132:135], v[68:71], v[52:55], v[132:135]
    ds_read_b128 v[28:31], v2 offset:6144
    v_mfma_f32_16x16x32_bf16 v[148:151], v[68:71], v[56:59], v[148:151]
    ds_read_b64_tr_b16 v[36:37], v4 offset:16384
    v_mfma_f32_16x16x32_bf16 v[164:167], v[68:71], v[60:63], v[164:167]
    ds_read_b64_tr_b16 v[38:39], v4 offset:18432
    v_mfma_f32_16x16x32_bf16 v[120:123], v[72:75], v[48:51], v[120:123]
    ds_read_b64_tr_b16 v[40:41], v5 offset:16384
    v_mfma_f32_16x16x32_bf16 v[136:139], v[72:75], v[52:55], v[136:139]
    ds_read_b64_tr_b16 v[42:43], v5 offset:18432
    v_mfma_f32_16x16x32_bf16 v[152:155], v[72:75], v[56:59], v[152:155]
    ds_read_b64_tr_b16 v[44:45], v6 offset:16384
    v_mfma_f32_16x16x32_bf16 v[168:171], v[72:75], v[60:63], v[168:171]
    ds_read_b64_tr_b16 v[46:47], v6 offset:18432
    v_mfma_f32_16x16x32_bf16 v[124:127], v[76:79], v[48:51], v[124:127]
    v_mfma_f32_16x16x32_bf16 v[140:143], v[76:79], v[52:55], v[140:143]
    v_mfma_f32_16x16x32_bf16 v[156:159], v[76:79], v[56:59], v[156:159]
    v_mfma_f32_16x16x32_bf16 v[172:175], v[76:79], v[60:63], v[172:175]
    s_cmp_lg_u32 s19, 0
    s_cbranch_scc1 K4_cloop
    s_waitcnt lgkmcnt(9)
    v_mfma_f32_16x16x32_bf16 v[112:115], v[32:35], v[16:19], v[112:115]
    ds_read_b128 v[48:51], v2 offset:1024
    s_waitcnt lgkmcnt(9)
    v_mfma_f32_16x16x32_bf16 v[128:131], v[32:35], v[20:23], v[128:131]
    ds_read_b64_tr_b16 v[64:65], v3 offset:20480
    s_waitcnt lgkmcnt(9)
    v_mfma_f32_16x16x32_bf16 v[144:147], v[32:35], v[24:27], v[144:147]
    ds_read_b64_tr_b16 v[66:67], v3 offset:22528
    s_waitcnt lgkmcnt(9)
    v_mfma_f32_16x16x32_bf16 v[160:163], v[32:35], v[28:31], v[160:163]
    ds_read_b128 v[52:55], v2 offset:3072
    s_waitcnt lgkmcnt(8)
    v_mfma_f32_16x16x32_bf16 v[116:119], v[36:39], v[16:19], v[116:119]
    ds_read_b128 v[56:59], v2 offset:5120
    v_mfma_f32_16x16x32_bf16 v[132:135], v[36:39], v[20:23], v[132:135]
    ds_read_b128 v[60:63], v2 offset:7168
    v_mfma_f32_16x16x32_bf16 v[148:151], v[36:39], v[24:27], v[148:151]
    ds_read_b64_tr_b16 v[68:69], v4 offset:20480
    v_mfma_f32_16x16x32_bf16 v[164:167], v[36:39], v[28:31], v[164:167]
    ds_read_b64_tr_b16 v[70:71], v4 offset:22528
    s_waitcnt lgkmcnt(10)
    v_mfma_f32_16x16x32_bf16 v[120:123], v[40:43], v[16:19], v[120:123]
    ds_read_b64_tr_b16 v[72:73], v5 offset:20480
    v_mfma_f32_16x16x32_bf16 v[136:139], v[40:43], v[20:23], v[136:139]
    ds_read_b64_tr_b16 v[74:75], v5 offset:22528
    v_mfma_f32_16x16x32_bf16 v[152:155], v[40:43], v[24:27], v[152:155]
    ds_read_b64_tr_b16 v[76:77], v6 offset:20480
    v_mfma_f32_16x16x32_bf16 v[168:171], v[40:43], v[28:31], v[168:171]
    ds_read_b64_tr_b16 v[78:79], v6 offset:22528
    s_waitcnt lgkmcnt(12)
    v_mfma_f32_16x16x32_bf16 v[124:127], v[44:47], v[16:19], v[124:127]
    v_mfma_f32_16x16x32_bf16 v[140:143], v[44:47], v[20:23], v[140:143]
    v_mfma_f32_16x16x32_bf16 v[156:159], v[44:47], v[24:27], v[156:159]
    v_mfma_f32_16x16x32_bf16 v[172:175], v[44:47], v[28:31], v[172:175]
    s_waitcnt lgkmcnt(9)
    v_mfma_f32_16x16x32_bf16 v[112:115], v[64:67], v[48:51], v[112:115]
    s_waitcnt lgkmcnt(8)
    v_mfma_f32_16x16x32_bf16 v[128:131], v[64:67], v[52:55], v[128:131]
    s_waitcnt lgkmcnt(7)
    v_mfma_f32_16x16x32_bf16 v[144:147], v[64:67], v[56:59], v[144:147]
    s_waitcnt lgkmcnt(6)
    v_mfma_f32_16x16x32_bf16 v[160:163], v[64:67], v[60:63], v[160:163]
    s_waitcnt lgkmcnt(4)
    v_mfma_f32_16x16x32_bf16 v[116:119], v[68:71], v[48:51], v[116:119]
    v_mfma_f32_16x16x32_bf16 v[132:135], v[68:71], v[52:55], v[132:135]
    v_mfma_f32_16x16x32_bf16 v[148:151], v[68:71], v[56:59], v[148:151]
    v_mfma_f32_16x16x32_bf16 v[164:167], v[68:71], v[60:63], v[164:167]
    s_waitcnt lgkmcnt(2)
    v_mfma_f32_16x16x32_bf16 v[120:123], v[72:75], v[48:51], v[120:123]
    v_mfma_f32_16x16x32_bf16 v[136:139], v[72:75], v[52:55], v[136:139]
    v_mfma_f32_16x16x32_bf16 v[152:155], v[72:75], v[56:59], v[152:155]
    v_mfma_f32_16x16x32_bf16 v[168:171], v[72:75], v[60:63], v[168:171]
    s_waitcnt lgkmcnt(0)
    v_mfma_f32_16x16x32_bf16 v[124:127], v[76:79], v[48:51], v[124:127]
    v_mfma_f32_16x16x32_bf16 v[140:143], v[76:79], v[52:55], v[140:143]
    v_mfma_f32_16x16x32_bf16 v[156:159], v[76:79], v[56:59], v[156:159]
    v_mfma_f32_16x16x32_bf16 v[172:175], v[76:79], v[60:63], v[172:175]
    s_add_u32 s40, s34, 0x3000000
    s_addc_u32 s41, s35, 0
    s_mov_b32 s42, 0x800000
    s_mov_b32 s43, 0x20000
    s_add_u32 s64, s34, 0x1e00000
    s_addc_u32 s65, s35, 0
    s_mov_b32 s66, 0x20000
    s_mov_b32 s67, 0x20000
    s_lshl_b32 s46, s17, 3
    s_add_u32 s46, s46, s18
    s_lshl_b32 s46, s46, 1
    s_xor_b32 s47, s30, 1
    s_add_u32 s47, s47, s46
    s_add_u32 s46, s46, s30
    s_lshl_b32 s60, s47, 2
    s_add_u32 s60, s60, s16
    s_lshl_b32 s60, s60, 13
    s_lshl_b32 s61, s46, 2
    s_add_u32 s61, s61, s16
    s_lshl_b32 s61, s61, 13
    v_lshlrev_b32 v11, 4, v1
    v_add_u32 v13, s61, v11
    v_add_u32 v11, s60, v11
    s_add_u32 s47, s47, 128
    s_lshl_b32 s47, s47, 8
    s_add_u32 s46, s46, 128
    s_lshl_b32 s46, s46, 8
    s_cmp_eq_u32 s30, 0
    s_cbranch_scc0 K4_kh1
    buffer_store_dwordx4 v[120:123], v11, s[40:43], 0 offen offset:0 sc1
    buffer_store_dwordx4 v[124:127], v11, s[40:43], 0 offen offset:1024 sc1
    buffer_store_dwordx4 v[136:139], v11, s[40:43], 0 offen offset:2048 sc1
    buffer_store_dwordx4 v[140:143], v11, s[40:43], 0 offen offset:3072 sc1
    v_add_u32 v11, 4096, v11
    buffer_store_dwordx4 v[152:155], v11, s[40:43], 0 offen offset:0 sc1
    buffer_store_dwordx4 v[156:159], v11, s[40:43], 0 offen offset:1024 sc1
    buffer_store_dwordx4 v[168:171], v11, s[40:43], 0 offen offset:2048 sc1
    buffer_store_dwordx4 v[172:175], v11, s[40:43], 0 offen offset:3072 sc1
    v_mov_b32 v16, v112
    v_mov_b32 v17, v113
    v_mov_b32 v18, v114
    v_mov_b32 v19, v115
    v_mov_b32 v20, v116
    v_mov_b32 v21, v117
    v_mov_b32 v22, v118
    v_mov_b32 v23, v119
    v_mov_b32 v24, v128
    v_mov_b32 v25, v129
    v_mov_b32 v26, v130
    v_mov_b32 v27, v131
    v_mov_b32 v28, v132
    v_mov_b32 v29, v133
    v_mov_b32 v30, v134
    v_mov_b32 v31, v135
    v_mov_b32 v32, v144
    v_mov_b32 v33, v145
    v_mov_b32 v34, v146
    v_mov_b32 v35, v147
    v_mov_b32 v36, v148
    v_mov_b32 v37, v149
    v_mov_b32 v38, v150
    v_mov_b32 v39, v151
    v_mov_b32 v40, v160
    v_mov_b32 v41, v161
    v_mov_b32 v42, v162
    v_mov_b32 v43, v163
    v_mov_b32 v44, v164
    v_mov_b32 v45, v165
    v_mov_b32 v46, v166
    v_mov_b32 v47, v167
    s_branch K4_sent
K4_kh1:
    buffer_store_dwordx4 v[112:115], v11, s[40:43], 0 offen offset:0 sc1
    buffer_store_dwordx4 v[116:119], v11, s[40:43], 0 offen offset:1024 sc1
    buffer_store_dwordx4 v[128:131], v11, s[40:43], 0 offen offset:2048 sc1
    buffer_store_dwordx4 v[132:135], v11, s[40:43], 0 offen offset:3072 sc1
    v_add_u32 v11, 4096, v11
    buffer_store_dwordx4 v[144:147], v11, s[40:43], 0 offen offset:0 sc1
    buffer_store_dwordx4 v[148:151], v11, s[40:43], 0 offen offset:1024 sc1
    buffer_store_dwordx4 v[160:163], v11, s[40:43], 0 offen offset:2048 sc1
    buffer_store_dwordx4 v[164:167], v11, s[40:43], 0 offen offset:3072 sc1
    v_mov_b32 v16, v120
    v_mov_b32 v17, v121
    v_mov_b32 v18, v122
    v_mov_b32 v19, v123
    v_mov_b32 v20, v124
    v_mov_b32 v21, v125
    v_mov_b32 v22, v126
    v_mov_b32 v23, v127
    v_mov_b32 v24, v136
    v_mov_b32 v25, v137
    v_mov_b32 v26, v138
    v_mov_b32 v27, v139
    v_mov_b32 v28, v140
    v_mov_b32 v29, v141
    v_mov_b32 v30, v142
    v_mov_b32 v31, v143
    v_mov_b32 v32, v152
    v_mov_b32 v33, v153
    v_mov_b32 v34, v154
    v_mov_b32 v35, v155
    v_mov_b32 v36, v156
    v_mov_b32 v37, v157
    v_mov_b32 v38, v158
    v_mov_b32 v39, v159
    v_mov_b32 v40, v168
    v_mov_b32 v41, v169
    v_mov_b32 v42, v170
    v_mov_b32 v43, v171
    v_mov_b32 v44, v172
    v_mov_b32 v45, v173
    v_mov_b32 v46, v174
    v_mov_b32 v47, v175
K4_sent:
    s_waitcnt vmcnt(8)
    v_lshlrev_b32 v212, 16, v208
    v_and_b32 v213, 0xffff0000, v208
    v_lshlrev_b32 v214, 16, v209
    v_and_b32 v215, 0xffff0000, v209
    v_lshlrev_b32 v216, 16, v210
    v_and_b32 v217, 0xffff0000, v210
    v_lshlrev_b32 v218, 16, v211
    v_and_b32 v219, 0xffff0000, v211
    v_lshlrev_b32 v48, 16, v192
    v_and_b32 v49, 0xffff0000, v192
    v_lshlrev_b32 v50, 16, v193
    v_and_b32 v51, 0xffff0000, v193
    v_lshlrev_b32 v52, 16, v194
    v_and_b32 v53, 0xffff0000, v194
    v_lshlrev_b32 v54, 16, v195
    v_and_b32 v55, 0xffff0000, v195
    v_lshlrev_b32 v56, 16, v196
    v_and_b32 v57, 0xffff0000, v196
    v_lshlrev_b32 v58, 16, v197
    v_and_b32 v59, 0xffff0000, v197
    v_lshlrev_b32 v60, 16, v198
    v_and_b32 v61, 0xffff0000, v198
    v_lshlrev_b32 v62, 16, v199
    v_and_b32 v63, 0xffff0000, v199
    v_lshlrev_b32 v64, 16, v200
    v_and_b32 v65, 0xffff0000, v200
    v_lshlrev_b32 v66, 16, v201
    v_and_b32 v67, 0xffff0000, v201
    v_lshlrev_b32 v68, 16, v202
    v_and_b32 v69, 0xffff0000, v202
    v_lshlrev_b32 v70, 16, v203
    v_and_b32 v71, 0xffff0000, v203
    v_lshlrev_b32 v72, 16, v204
    v_and_b32 v73, 0xffff0000, v204
    v_lshlrev_b32 v74, 16, v205
    v_and_b32 v75, 0xffff0000, v205
    v_lshlrev_b32 v76, 16, v206
    v_and_b32 v77, 0xffff0000, v206
    v_lshlrev_b32 v78, 16, v207
    v_and_b32 v79, 0xffff0000, v207
    v_pk_add_f32 v[16:17], v[16:17], v[212:213]
    v_pk_add_f32 v[18:19], v[18:19], v[214:215]
    v_pk_add_f32 v[20:21], v[20:21], v[216:217]
    v_pk_add_f32 v[22:23], v[22:23], v[218:219]
    v_pk_add_f32 v[24:25], v[24:25], v[212:213]
    v_pk_add_f32 v[26:27], v[26:27], v[214:215]
    v_pk_add_f32 v[28:29], v[28:29], v[216:217]
    v_pk_add_f32 v[30:31], v[30:31], v[218:219]
    v_pk_add_f32 v[32:33], v[32:33], v[212:213]
    v_pk_add_f32 v[34:35], v[34:35], v[214:215]
    v_pk_add_f32 v[36:37], v[36:37], v[216:217]
    v_pk_add_f32 v[38:39], v[38:39], v[218:219]
    v_pk_add_f32 v[40:41], v[40:41], v[212:213]
    v_pk_add_f32 v[42:43], v[42:43], v[214:215]
    v_pk_add_f32 v[44:45], v[44:45], v[216:217]
    v_pk_add_f32 v[46:47], v[46:47], v[218:219]
    v_pk_add_f32 v[16:17], v[16:17], v[48:49]
    v_pk_add_f32 v[18:19], v[18:19], v[50:51]
    v_pk_add_f32 v[20:21], v[20:21], v[52:53]
    v_pk_add_f32 v[22:23], v[22:23], v[54:55]
    v_pk_add_f32 v[24:25], v[24:25], v[56:57]
    v_pk_add_f32 v[26:27], v[26:27], v[58:59]
    v_pk_add_f32 v[28:29], v[28:29], v[60:61]
    v_pk_add_f32 v[30:31], v[30:31], v[62:63]
    v_pk_add_f32 v[32:33], v[32:33], v[64:65]
    v_pk_add_f32 v[34:35], v[34:35], v[66:67]
    v_pk_add_f32 v[36:37], v[36:37], v[68:69]
    v_pk_add_f32 v[38:39], v[38:39], v[70:71]
    v_pk_add_f32 v[40:41], v[40:41], v[72:73]
    v_pk_add_f32 v[42:43], v[42:43], v[74:75]
    v_pk_add_f32 v[44:45], v[44:45], v[76:77]
    v_pk_add_f32 v[46:47], v[46:47], v[78:79]
    s_waitcnt vmcnt(0)
    s_barrier
    s_cmp_lg_u32 s16, 0
    s_cbranch_scc1 K4_nopoll
    v_mov_b32 v80, 1
    v_mov_b32 v81, 0
    s_mov_b64 s[78:79], exec
    s_mov_b64 exec, 1
    buffer_atomic_add v80, v81, s[64:67], s47 offen
    s_mov_b64 exec, s[78:79]
    s_mov_b32 s77, 0x40000
    v_mov_b32 v81, 0
K4_p:
    buffer_load_dword v80, v81, s[64:67], s46 offen sc1
    s_waitcnt vmcnt(0)
    v_readfirstlane_b32 s78, v80
    s_nop 3
    s_cmp_ge_u32 s78, 1
    s_cbranch_scc1 K4_p_done
    s_sleep 1
    s_sub_u32 s77, s77, 1
    s_cmp_lg_u32 s77, 0
    s_cbranch_scc1 K4_p
K4_p_done:
K4_nopoll:
    s_barrier
    buffer_load_dwordx4 v[48:51], v13, s[40:43], 0 offen offset:0 sc1
    buffer_load_dwordx4 v[52:55], v13, s[40:43], 0 offen offset:1024 sc1
    buffer_load_dwordx4 v[56:59], v13, s[40:43], 0 offen offset:2048 sc1
    buffer_load_dwordx4 v[60:63], v13, s[40:43], 0 offen offset:3072 sc1
    v_add_u32 v13, 4096, v13
    buffer_load_dwordx4 v[64:67], v13, s[40:43], 0 offen offset:0 sc1
    buffer_load_dwordx4 v[68:71], v13, s[40:43], 0 offen offset:1024 sc1
    buffer_load_dwordx4 v[72:75], v13, s[40:43], 0 offen offset:2048 sc1
    buffer_load_dwordx4 v[76:79], v13, s[40:43], 0 offen offset:3072 sc1
    s_mov_b32 s45, 0
    s_waitcnt vmcnt(6)
    v_pk_add_f32 v[16:17], v[16:17], v[48:49]
    v_pk_add_f32 v[18:19], v[18:19], v[50:51]
    v_pk_add_f32 v[20:21], v[20:21], v[52:53]
    v_pk_add_f32 v[22:23], v[22:23], v[54:55]
    v_cvt_pk_bf16_f32 v112, v16, v17
    v_cvt_pk_bf16_f32 v113, v18, v19
    v_cvt_pk_bf16_f32 v114, v20, v21
    v_cvt_pk_bf16_f32 v115, v22, v23
    s_nop 0
    v_permlane16_swap_b32 v112, v114
    v_permlane16_swap_b32 v113, v115
    buffer_store_dwordx4 v[112:115], v9, s[52:55], s45 offen sc1
    s_add_u32 s45, s45, 32768
    s_waitcnt vmcnt(5)
    v_pk_add_f32 v[24:25], v[24:25], v[56:57]
    v_pk_add_f32 v[26:27], v[26:27], v[58:59]
    v_pk_add_f32 v[28:29], v[28:29], v[60:61]
    v_pk_add_f32 v[30:31], v[30:31], v[62:63]
    v_cvt_pk_bf16_f32 v116, v24, v25
    v_cvt_pk_bf16_f32 v117, v26, v27
    v_cvt_pk_bf16_f32 v118, v28, v29
    v_cvt_pk_bf16_f32 v119, v30, v31
    s_nop 0
    v_permlane16_swap_b32 v116, v118
    v_permlane16_swap_b32 v117, v119
    buffer_store_dwordx4 v[116:119], v9, s[52:55], s45 offen sc1
    s_add_u32 s45, s45, 32768
    s_waitcnt vmcnt(4)
    v_pk_add_f32 v[32:33], v[32:33], v[64:65]
    v_pk_add_f32 v[34:35], v[34:35], v[66:67]
    v_pk_add_f32 v[36:37], v[36:37], v[68:69]
    v_pk_add_f32 v[38:39], v[38:39], v[70:71]
    v_cvt_pk_bf16_f32 v120, v32, v33
    v_cvt_pk_bf16_f32 v121, v34, v35
    v_cvt_pk_bf16_f32 v122, v36, v37
    v_cvt_pk_bf16_f32 v123, v38, v39
    s_nop 0
    v_permlane16_swap_b32 v120, v122
    v_permlane16_swap_b32 v121, v123
    buffer_store_dwordx4 v[120:123], v9, s[52:55], s45 offen sc1
    s_add_u32 s45, s45, 32768
    s_waitcnt vmcnt(3)
    v_pk_add_f32 v[40:41], v[40:41], v[72:73]
    v_pk_add_f32 v[42:43], v[42:43], v[74:75]
    v_pk_add_f32 v[44:45], v[44:45], v[76:77]
    v_pk_add_f32 v[46:47], v[46:47], v[78:79]
    v_cvt_pk_bf16_f32 v124, v40, v41
    v_cvt_pk_bf16_f32 v125, v42, v43
    v_cvt_pk_bf16_f32 v126, v44, v45
    v_cvt_pk_bf16_f32 v127, v46, v47
    s_nop 0
    v_permlane16_swap_b32 v124, v126
    v_permlane16_swap_b32 v125, v127
    buffer_store_dwordx4 v[124:127], v9, s[52:55], s45 offen sc1
    s_branch K4_end
K4_loader:
    s_sub_u32 s23, s16, 4
    v_lshlrev_b32 v2, 4, v1
    s_mul_i32 s24, s23, 2
    s_add_u32 s24, s24, s44
    s_mul_i32 s24, s24, 114688
    v_add_u32 v3, s24, v2
    s_add_u32 s24, s24, 114688
    v_add_u32 v4, s24, v2
    s_mov_b32 s24, 2048
    v_lshrrev_b32 v5, 3, v1
    v_mul_lo_u32 v7, v5, s24
    v_bfe_u32 v5, v1, 4, 2
    v_lshlrev_b32 v5, 1, v5
    v_and_b32 v6, 7, v1
    v_xor_b32 v5, v5, v6
    v_lshl_add_u32 v7, v5, 4, v7
    s_mul_i32 s25, s23, 32768
    s_add_u32 s24, s25, s45
    v_add_u32 v8, s24, v7
    v_add_u32 v9, 15360, v8
    s_add_u32 s24, s25, s48
    v_add_u32 v10, s24, v7
    v_add_u32 v11, 15360, v10
    s_mul_i32 s27, s23, 4096
    s_lshl_b32 s28, s23, 11
    s_add_u32 s56, s34, 0x1e00000
    s_addc_u32 s57, s35, 0
    s_mov_b32 s58, 0x10000
    s_mov_b32 s59, 0x20000
    s_mov_b32 s20, 0
    s_mov_b32 s21, s46
    s_mov_b32 s22, s47
    s_add_u32 s24, s20, s28
    s_add_u32 m0, s24, 16384
    s_nop 0
    buffer_load_dwordx4 v8, s[8:11], s22 offen offset:0  lds
    buffer_load_dwordx4 v9, s[8:11], s22 offen offset:1024  lds
    s_add_u32 m0, s24, 24576
    s_nop 0
    buffer_load_dwordx4 v10, s[8:11], s22 offen offset:0  lds
    buffer_load_dwordx4 v11, s[8:11], s22 offen offset:1024  lds
    s_mov_b32 s20, 32768
    s_add_u32 s22, s22, 131072
    s_add_u32 s24, s20, s28
    s_add_u32 m0, s24, 16384
    s_nop 0
    buffer_load_dwordx4 v8, s[8:11], s22 offen offset:0  lds
    buffer_load_dwordx4 v9, s[8:11], s22 offen offset:1024  lds
    s_add_u32 m0, s24, 24576
    s_nop 0
    buffer_load_dwordx4 v10, s[8:11], s22 offen offset:0  lds
    buffer_load_dwordx4 v11, s[8:11], s22 offen offset:1024  lds
    s_add_u32 s22, s22, 131072
    s_barrier
    s_lshl_b32 s41, s17, 1
    s_add_u32 s41, s41, s30
    s_add_u32 s41, s41, 96
    s_lshl_b32 s41, s41, 8
    s_mov_b32 s77, 0x40000
    v_mov_b32 v205, 0
K4_g:
    buffer_load_dword v204, v205, s[56:59], s41 offen sc1
    s_waitcnt vmcnt(0)
    v_readfirstlane_b32 s78, v204
    s_nop 3
    s_cmp_ge_u32 s78, 8
    s_cbranch_scc1 K4_g_done
    s_sleep 1
    s_sub_u32 s77, s77, 1
    s_cmp_lg_u32 s77, 0
    s_cbranch_scc1 K4_g
K4_g_done:
    s_mov_b32 s20, 0
    s_add_u32 m0, s20, s27
    s_nop 0
    buffer_load_dwordx4 v3, s[4:7], s21 offen offset:0  lds
    buffer_load_dwordx4 v3, s[4:7], s21 offen offset:1024  lds
    s_add_u32 m0, m0, 2048
    s_nop 0
    buffer_load_dwordx4 v4, s[4:7], s21 offen offset:0  lds
    buffer_load_dwordx4 v4, s[4:7], s21 offen offset:1024  lds
    s_mov_b32 s20, 32768
    s_add_u32 s21, s21, 2048
    s_add_u32 m0, s20, s27
    s_nop 0
    buffer_load_dwordx4 v3, s[4:7], s21 offen offset:0  lds
    buffer_load_dwordx4 v3, s[4:7], s21 offen offset:1024  lds
    s_add_u32 m0, m0, 2048
    s_nop 0
    buffer_load_dwordx4 v4, s[4:7], s21 offen offset:0  lds
    buffer_load_dwordx4 v4, s[4:7], s21 offen offset:1024  lds
    s_add_u32 s21, s21, 2048
    s_mov_b32 s20, 65536
    s_waitcnt vmcnt(4)
    s_barrier
    s_add_u32 m0, s20, s27
    s_nop 0
    buffer_load_dwordx4 v3, s[4:7], s21 offen offset:0  lds
    buffer_load_dwordx4 v3, s[4:7], s21 offen offset:1024  lds
    s_add_u32 m0, m0, 2048
    s_nop 0
    buffer_load_dwordx4 v4, s[4:7], s21 offen offset:0  lds
    buffer_load_dwordx4 v4, s[4:7], s21 offen offset:1024  lds
    s_add_u32 s24, s20, s28
    s_add_u32 m0, s24, 16384
    s_nop 0
    buffer_load_dwordx4 v8, s[8:11], s22 offen offset:0  lds
    buffer_load_dwordx4 v9, s[8:11], s22 offen offset:1024  lds
    s_add_u32 m0, s24, 24576
    s_nop 0
    buffer_load_dwordx4 v10, s[8:11], s22 offen offset:0  lds
    buffer_load_dwordx4 v11, s[8:11], s22 offen offset:1024  lds
    s_add_u32 s21, s21, 2048
    s_add_u32 s22, s22, 131072
    s_add_u32 s20, s20, 32768
    s_cmp_eq_u32 s20, 131072
    s_cselect_b32 s20, 0, s20
    s_add_u32 m0, s20, s27
    s_nop 0
    buffer_load_dwordx4 v3, s[4:7], s21 offen offset:0  lds
    buffer_load_dwordx4 v3, s[4:7], s21 offen offset:1024  lds
    s_add_u32 m0, m0, 2048
    s_nop 0
    buffer_load_dwordx4 v4, s[4:7], s21 offen offset:0  lds
    buffer_load_dwordx4 v4, s[4:7], s21 offen offset:1024  lds
    s_add_u32 s24, s20, s28
    s_add_u32 m0, s24, 16384
    s_nop 0
    buffer_load_dwordx4 v8, s[8:11], s22 offen offset:0  lds
    buffer_load_dwordx4 v9, s[8:11], s22 offen offset:1024  lds
    s_add_u32 m0, s24, 24576
    s_nop 0
    buffer_load_dwordx4 v10, s[8:11], s22 offen offset:0  lds
    buffer_load_dwordx4 v11, s[8:11], s22 offen offset:1024  lds
    s_add_u32 s21, s21, 2048
    s_add_u32 s22, s22, 131072
    s_add_u32 s20, s20, 32768
    s_cmp_eq_u32 s20, 131072
    s_cselect_b32 s20, 0, s20
    s_mov_b32 s19, 24
K4_lloop:
    s_waitcnt vmcnt(16)
    s_barrier
    s_add_u32 m0, s20, s27
    s_nop 0
    buffer_load_dwordx4 v3, s[4:7], s21 offen offset:0  lds
    buffer_load_dwordx4 v3, s[4:7], s21 offen offset:1024  lds
    s_add_u32 m0, m0, 2048
    s_nop 0
    buffer_load_dwordx4 v4, s[4:7], s21 offen offset:0  lds
    buffer_load_dwordx4 v4, s[4:7], s21 offen offset:1024  lds
    s_add_u32 s24, s20, s28
    s_add_u32 m0, s24, 16384
    s_nop 0
    buffer_load_dwordx4 v8, s[8:11], s22 offen offset:0  lds
    buffer_load_dwordx4 v9, s[8:11], s22 offen offset:1024  lds
    s_add_u32 m0, s24, 24576
    s_nop 0
    buffer_load_dwordx4 v10, s[8:11], s22 offen offset:0  lds
    buffer_load_dwordx4 v11, s[8:11], s22 offen offset:1024  lds
    s_add_u32 s21, s21, 2048
    s_add_u32 s22, s22, 131072
    s_add_u32 s20, s20, 32768
    s_cmp_eq_u32 s20, 131072
    s_cselect_b32 s20, 0, s20
K4_hookret:
    s_sub_u32 s19, s19, 1
    s_cmp_lg_u32 s19, 0
    s_cbranch_scc1 K4_lloop
    s_waitcnt vmcnt(16)
    s_barrier
    s_waitcnt vmcnt(8)
    s_barrier
    s_waitcnt vmcnt(0)
    s_barrier
K4_end:
    s_endpgm
CODE_END:
.section .rodata,"a"
.p2align 6
.amdhsa_kernel k0_kernel
  .amdhsa_next_free_vgpr 128
  .amdhsa_next_free_sgpr 102
  .amdhsa_accum_offset 128
  .amdhsa_group_segment_fixed_size 0
  .amdhsa_kernarg_size 96
  .amdhsa_user_sgpr_count 2
  .amdhsa_user_sgpr_kernarg_segment_ptr 1
  .amdhsa_system_sgpr_workgroup_id_x 1
  .amdhsa_float_denorm_mode_32 3
  .amdhsa_float_denorm_mode_16_64 3
.end_amdhsa_kernel
.p2align 6
.amdhsa_kernel ka_kernel
  .amdhsa_next_free_vgpr 256
  .amdhsa_next_free_sgpr 102
  .amdhsa_accum_offset 256
  .amdhsa_group_segment_fixed_size 0
  .amdhsa_kernarg_size 96
  .amdhsa_user_sgpr_count 2
  .amdhsa_user_sgpr_kernarg_segment_ptr 1
  .amdhsa_system_sgpr_workgroup_id_x 1
  .amdhsa_float_denorm_mode_32 3
  .amdhsa_float_denorm_mode_16_64 3
.end_amdhsa_kernel
```
